```python
import torch

def _softmax(x, axis=-1):
    return torch.softmax(x, dim=axis)
def _gelu(x):
    return torch.nn.functional.gelu(x, approximate="tanh")
def _silu(x):
    return torch.nn.functional.silu(x)
def _sigmoid(x):
    return torch.sigmoid(x)
def _layernorm(x, axis=-1, eps=1e-5):
    m = x.mean(dim=axis, keepdim=True)
    v = x.var(dim=axis, keepdim=True, unbiased=False)
    return (x - m) / torch.sqrt(v + eps)
def _scatter_add(tgt, idx, src, axis=0):
    return tgt.clone().index_add_(axis, idx, src)
def _segment_sum(src, seg, n):
    out = torch.zeros((n,) + src.shape[1:], dtype=src.dtype)
    return out.index_add_(0, seg, src)
def _pad(x, pw):
    flat = tuple(v for pair in reversed(pw) for v in pair)
    return torch.nn.functional.pad(x, flat)

kernel_name = 'sequential_preLN__mha_block_cached__glu_gated_bilinear__decode'

def setup_inputs():

    _w = (lambda a: (lambda t: t.to(torch.bfloat16) if t.is_floating_point() else t)(torch.as_tensor(a)))
    def _A_setup():
        B, Sq, D = 1, 1, 576
        H, Sk, Dh = 32, 32768, 128
        return {
            "x": _w((lambda *s: torch.randn(*s, dtype=torch.bfloat16) * 0.05)(B, Sq, D)),
            "k_cache": _w((lambda *s: torch.randn(*s, dtype=torch.bfloat16) * 3.2)(B, H, Sk, Dh)),
            "v_cache": _w((lambda *s: torch.randn(*s, dtype=torch.bfloat16) * 1.6)(B, H, Sk, Dh)),
            "wq": _w((lambda *s: torch.randn(*s, dtype=torch.bfloat16) * 3.2)(D, H * Dh) * (D ** -0.5)),
            "wo": _w((lambda *s: torch.randn(*s, dtype=torch.bfloat16) * 1.6)(H * Dh, D) * ((H * Dh) ** -0.5)),
        }
    _A_in = _A_setup()

    def _B_setup():
        B, S, D, F = 1, 1, 576, 4608
        return {
            "x": _w((lambda *s: torch.randn(*s, dtype=torch.bfloat16) * 0.05)(B, S, D)),
            "w_gate": _w((lambda *s: torch.randn(*s, dtype=torch.bfloat16) * 1.6)(D, F) * (D ** -0.5)),
            "w_up": _w((lambda *s: torch.randn(*s, dtype=torch.bfloat16) * 1.6)(D, F) * (D ** -0.5)),
            "w_down": _w((lambda *s: torch.randn(*s, dtype=torch.bfloat16) * 1.6)(F, D) * (F ** -0.5)),
        }
    _B_in = _B_setup()

    return {
        "A_x": _A_in["x"],
        "A_k_cache": _A_in["k_cache"],
        "A_v_cache": _A_in["v_cache"],
        "A_wq": _A_in["wq"],
        "A_wo": _A_in["wo"],
        "B_x": _B_in["x"],
        "B_w_gate": _B_in["w_gate"],
        "B_w_up": _B_in["w_up"],
        "B_w_down": _B_in["w_down"],
    }

def reference(A_x, A_k_cache, A_v_cache, A_wq, A_wo, B_x, B_w_gate, B_w_up, B_w_down):
    def _A_ref(x, k_cache, v_cache, wq, wo):
        B, Sq, D = x.shape
        H, Dh = 32, 128
        q = (lambda x, *d: x.permute(*d))((x @ wq).reshape(B, Sq, H, Dh), 0, 2, 1, 3)
        scores = torch.einsum("bhqd,bhkd->bhqk", q, k_cache) * (Dh ** -0.5)
        p = _softmax(scores, axis=-1)
        o = torch.einsum("bhqk,bhkd->bhqd", p, v_cache)
        return (lambda x, *d: x.permute(*d))(o, 0, 2, 1, 3).reshape(B, Sq, H * Dh) @ wo

    def _B_ref(x, w_gate, w_up, w_down):
        g = torch.einsum("bsd,df->bsf", x, w_gate)
        u = torch.einsum("bsd,df->bsf", x, w_up)
        h = g * u
        return torch.einsum("bsf,fd->bsd", h, w_down)

    x = A_x
    h = x + _A_ref(_layernorm(x, axis=-1), A_k_cache, A_v_cache, A_wq, A_wo)
    h2 = h + _B_ref(_layernorm(h, axis=-1), B_w_gate, B_w_up, B_w_down)
    return h2
```

```asm
; @launch grid=(256,1,1) block=(512,1,1) lds=16384
.amdgcn_target "amdgcn-amd-amdhsa--gfx950"
.text
.globl sequential_preLN__mha_block_cached__glu_gated_bilinear__decode_kernel
.p2align 8
.type sequential_preLN__mha_block_cached__glu_gated_bilinear__decode_kernel,@function
sequential_preLN__mha_block_cached__glu_gated_bilinear__decode_kernel:
    s_cmp_ge_u32 s2, 256
    s_cbranch_scc1 L_end
    s_load_dwordx16 s[16:31], s[0:1], 0
    s_load_dwordx8 s[32:39], s[0:1], 64
    v_lshrrev_b32 v1, 6, v0
    v_and_b32 v0, 63, v0
    v_readfirstlane_b32 s3, v1
    s_and_b32 s4, s2, 7
    s_lshr_b32 s5, s2, 3
    s_lshl_b32 s14, s4, 2
    s_add_u32 s6, s5, s14
    s_and_b32 s6, s6, 31
    s_lshl_b32 s8, s6, 3
    s_add_u32 s8, s8, s4
    s_mul_i32 s7, s4, 192
    s_movk_i32 s11, 0x1000
    v_lshlrev_b32 v53, 4, v0
    v_mov_b32 v54, 0
    s_cmp_lg_u32 s3, 0
    s_cbranch_scc1 L_notq
    s_setprio 3
    v_lshlrev_b32 v34, 1, v0
    v_lshrrev_b32 v38, 4, v0
    s_mul_i32 s14, s4, 72
    v_add_u32 v38, s14, v38
    v_and_b32 v39, 15, v0
    v_lshl_add_u32 v35, v39, 2, v38
    v_lshlrev_b32 v35, 1, v35
    v_lshlrev_b32 v37, 13, v38
    v_lshl_add_u32 v37, v39, 4, v37
    s_lshl_b32 s14, s6, 8
    v_add_u32 v37, s14, v37
    s_waitcnt lgkmcnt(0)
    s_mov_b32 s48, s16
    s_mov_b32 s49, s17
    s_mov_b32 s50, 0x480
    s_mov_b32 s51, 0x20000
    s_mov_b32 s52, s22
    s_mov_b32 s53, s23
    s_mov_b32 s54, 0x480000
    s_mov_b32 s55, 0x20000
    s_mov_b32 s56, s38
    s_mov_b32 s57, s39
    s_mov_b32 s58, 0x200000
    s_mov_b32 s59, 0x20000
    buffer_load_ushort v40, v34, s[48:51], 0 offen offset:0
    buffer_load_ushort v41, v34, s[48:51], 0 offen offset:128
    buffer_load_ushort v42, v34, s[48:51], 0 offen offset:256
    buffer_load_ushort v43, v34, s[48:51], 0 offen offset:384
    buffer_load_ushort v44, v34, s[48:51], 0 offen offset:512
    buffer_load_ushort v45, v34, s[48:51], 0 offen offset:640
    buffer_load_ushort v46, v34, s[48:51], 0 offen offset:768
    buffer_load_ushort v47, v34, s[48:51], 0 offen offset:896
    buffer_load_ushort v48, v34, s[48:51], 0 offen offset:1024
    buffer_load_ushort v49, v35, s[48:51], 0 offen
    buffer_load_ushort v50, v35, s[48:51], 0 offen offset:128
    s_mov_b32 s14, 983040
    buffer_load_dword v51, v54, s[56:59], s14 offen sc1
    s_mov_b32 s14, 0
    buffer_load_dwordx4 v[56:59], v37, s[52:55], s14 offen nt
    s_mov_b32 s14, 32768
    buffer_load_dwordx4 v[60:63], v37, s[52:55], s14 offen nt
    s_mov_b32 s14, 65536
    buffer_load_dwordx4 v[64:67], v37, s[52:55], s14 offen nt
    s_mov_b32 s14, 98304
    buffer_load_dwordx4 v[68:71], v37, s[52:55], s14 offen nt
    s_mov_b32 s14, 131072
    buffer_load_dwordx4 v[72:75], v37, s[52:55], s14 offen nt
    s_mov_b32 s14, 163840
    buffer_load_dwordx4 v[76:79], v37, s[52:55], s14 offen nt
    s_mov_b32 s14, 196608
    buffer_load_dwordx4 v[80:83], v37, s[52:55], s14 offen nt
    s_mov_b32 s14, 229376
    buffer_load_dwordx4 v[84:87], v37, s[52:55], s14 offen nt
    s_mov_b32 s14, 262144
    buffer_load_dwordx4 v[88:91], v37, s[52:55], s14 offen nt
    s_mov_b32 s14, 294912
    buffer_load_dwordx4 v[92:95], v37, s[52:55], s14 offen nt
    s_mov_b32 s14, 327680
    buffer_load_dwordx4 v[96:99], v37, s[52:55], s14 offen nt
    s_mov_b32 s14, 360448
    buffer_load_dwordx4 v[100:103], v37, s[52:55], s14 offen nt
    s_mov_b32 s14, 393216
    buffer_load_dwordx4 v[104:107], v37, s[52:55], s14 offen nt
    s_mov_b32 s14, 425984
    buffer_load_dwordx4 v[108:111], v37, s[52:55], s14 offen nt
    s_mov_b32 s14, 458752
    buffer_load_dwordx4 v[112:115], v37, s[52:55], s14 offen nt
    s_mov_b32 s14, 491520
    buffer_load_dwordx4 v[116:119], v37, s[52:55], s14 offen nt
    s_mov_b32 s14, 524288
    buffer_load_dwordx4 v[120:123], v37, s[52:55], s14 offen nt
    s_mov_b32 s14, 557056
    buffer_load_dwordx4 v[124:127], v37, s[52:55], s14 offen nt
L_notq:
    s_waitcnt lgkmcnt(0)
    s_lshl_b32 s14, s6, 23
    s_add_u32 s18, s18, s14
    s_addc_u32 s19, s19, 0
    s_add_u32 s20, s20, s14
    s_addc_u32 s21, s21, 0
    s_lshl_b32 s14, s7, 12
    s_lshl_b32 s15, s3, 13
    s_add_u32 s14, s14, s15
    v_add_u32 v1, s14, v53
    s_mov_b32 s40, s18
    s_mov_b32 s41, s19
    s_mov_b32 s42, 0x800000
    s_mov_b32 s43, 0x20000
    s_mov_b32 s44, s20
    s_mov_b32 s45, s21
    s_mov_b32 s46, 0x800000
    s_mov_b32 s47, 0x20000
    s_mov_b32 s48, s16
    s_mov_b32 s49, s17
    s_mov_b32 s50, 0x480
    s_mov_b32 s51, 0x20000
    s_mov_b32 s56, s38
    s_mov_b32 s57, s39
    s_mov_b32 s58, 0x200000
    s_mov_b32 s59, 0x20000
    s_mov_b32 s60, s36
    s_mov_b32 s61, s37
    s_mov_b32 s62, 0x100
    s_mov_b32 s63, 0x20000
    s_barrier
    s_mul_i32 s9, s4, 18
    s_add_u32 s9, s9, s5
    s_cmp_lt_u32 s5, 18
    s_cbranch_scc1 L_role
    s_sub_u32 s9, s5, 18
    s_cmp_lt_u32 s5, 27
    s_cbranch_scc1 L_role
    s_sub_u32 s9, s2, 216
L_role:
    s_mov_b32 s12, 0xaaaaaaaa
    s_mov_b32 s13, 0xaaaaaaaa
    s_cmp_lg_u32 s3, 0
    s_cbranch_scc1 L_loads
    v_and_b32 v32, 1, v0
    v_lshlrev_b32 v32, 4, v32
    v_mov_b32 v33, 0xffff
    v_lshlrev_b32 v32, v32, v33
    v_bfe_u32 v33, v0, 1, 2
    v_cmp_eq_u32 vcc, 0, v33
    s_nop 1
    v_cndmask_b32 v2, 0, v32, vcc
    v_cmp_eq_u32 vcc, 1, v33
    s_nop 1
    v_cndmask_b32 v3, 0, v32, vcc
    v_cmp_eq_u32 vcc, 2, v33
    s_nop 1
    v_cndmask_b32 v4, 0, v32, vcc
    v_cmp_eq_u32 vcc, 3, v33
    s_nop 1
    v_cndmask_b32 v5, 0, v32, vcc
    v_mov_b32 v32, 48
    ds_write_b32 v54, v32 offset:8512
    s_waitcnt vmcnt(18)
    v_lshlrev_b32 v40, 16, v40
    v_lshlrev_b32 v41, 16, v41
    v_lshlrev_b32 v42, 16, v42
    v_lshlrev_b32 v43, 16, v43
    v_lshlrev_b32 v44, 16, v44
    v_lshlrev_b32 v45, 16, v45
    v_lshlrev_b32 v46, 16, v46
    v_lshlrev_b32 v47, 16, v47
    v_lshlrev_b32 v48, 16, v48
    v_lshlrev_b32 v49, 16, v49
    v_lshlrev_b32 v50, 16, v50
    v_add_u32 v51, 0x9e3779b9, v51
    s_nop 0
    v_readfirstlane_b32 s89, v51
    v_readfirstlane_b32 s15, v40
    s_nop 1
    v_subrev_f32 v40, s15, v40
    v_subrev_f32 v41, s15, v41
    v_subrev_f32 v42, s15, v42
    v_subrev_f32 v43, s15, v43
    v_subrev_f32 v44, s15, v44
    v_subrev_f32 v45, s15, v45
    v_subrev_f32 v46, s15, v46
    v_subrev_f32 v47, s15, v47
    v_subrev_f32 v48, s15, v48
    v_add_f32 v32, v40, v41
    v_mul_f32 v33, v40, v40
    v_fmac_f32 v33, v41, v41
    v_add_f32 v32, v32, v42
    v_fmac_f32 v33, v42, v42
    v_add_f32 v32, v32, v43
    v_fmac_f32 v33, v43, v43
    v_add_f32 v32, v32, v44
    v_fmac_f32 v33, v44, v44
    v_add_f32 v32, v32, v45
    v_fmac_f32 v33, v45, v45
    v_add_f32 v32, v32, v46
    v_fmac_f32 v33, v46, v46
    v_add_f32 v32, v32, v47
    v_fmac_f32 v33, v47, v47
    v_add_f32 v32, v32, v48
    v_fmac_f32 v33, v48, v48
    s_nop 0
    v_add_f32_dpp v32, v32, v32 quad_perm:[1,0,3,2] row_mask:0xf bank_mask:0xf
    v_add_f32_dpp v33, v33, v33 quad_perm:[1,0,3,2] row_mask:0xf bank_mask:0xf
    s_nop 0
    v_add_f32_dpp v32, v32, v32 quad_perm:[2,3,0,1] row_mask:0xf bank_mask:0xf
    v_add_f32_dpp v33, v33, v33 quad_perm:[2,3,0,1] row_mask:0xf bank_mask:0xf
    s_nop 0
    v_add_f32_dpp v32, v32, v32 row_half_mirror row_mask:0xf bank_mask:0xf
    v_add_f32_dpp v33, v33, v33 row_half_mirror row_mask:0xf bank_mask:0xf
    s_nop 0
    v_add_f32_dpp v32, v32, v32 row_ror:8 row_mask:0xf bank_mask:0xf
    v_add_f32_dpp v33, v33, v33 row_ror:8 row_mask:0xf bank_mask:0xf
    v_mov_b32 v34, v32
    v_mov_b32 v35, v33
    s_nop 0
    v_permlane16_swap_b32 v34, v32
    v_permlane16_swap_b32 v35, v33
    v_add_f32 v32, v34, v32
    v_add_f32 v33, v35, v33
    v_mov_b32 v34, v32
    v_mov_b32 v35, v33
    s_nop 0
    v_permlane32_swap_b32 v34, v32
    v_permlane32_swap_b32 v35, v33
    v_add_f32 v32, v34, v32
    v_add_f32 v33, v35, v33
    v_mul_f32 v32, 0x3ae38e39, v32
    v_mul_f32 v33, 0x3ae38e39, v33
    v_fma_f32 v33, -v32, v32, v33
    v_add_f32 v32, s15, v32
    v_max_f32 v33, 0, v33
    v_cvt_pk_bf16_f32 v32, v32, v32
    v_and_b32 v32, 0xffff0000, v32
    v_cvt_pk_bf16_f32 v33, v33, v33
    v_and_b32 v33, 0xffff0000, v33
    v_sub_f32 v49, v49, v32
    v_sub_f32 v50, v50, v32
    v_add_f32 v33, 0x3727c5ac, v33
    v_cvt_pk_bf16_f32 v33, v33, v33
    v_and_b32 v33, 0xffff0000, v33
    v_sqrt_f32 v33, v33
    v_cvt_pk_bf16_f32 v49, v49, v49
    v_and_b32 v49, 0xffff0000, v49
    v_cvt_pk_bf16_f32 v50, v50, v50
    v_and_b32 v50, 0xffff0000, v50
    v_cvt_pk_bf16_f32 v33, v33, v33
    v_and_b32 v33, 0xffff0000, v33
    v_rcp_f32 v34, v33
    s_nop 0
    v_mul_f32 v35, v49, v34
    v_fma_f32 v49, -v35, v33, v49
    v_fma_f32 v49, v49, v34, v35
    v_cvt_pk_bf16_f32 v49, v49, v49
    v_mul_f32 v35, v50, v34
    v_fma_f32 v50, -v35, v33, v50
    v_fma_f32 v50, v50, v34, v35
    v_cvt_pk_bf16_f32 v50, v50, v50
    s_waitcnt vmcnt(0)
    v_and_b32_dpp v24, v49, v2 row_newbcast:0 row_mask:0xf bank_mask:0xf
    v_and_b32_dpp v25, v49, v3 row_newbcast:0 row_mask:0xf bank_mask:0xf
    v_and_b32_dpp v26, v49, v4 row_newbcast:0 row_mask:0xf bank_mask:0xf
    v_and_b32_dpp v27, v49, v5 row_newbcast:0 row_mask:0xf bank_mask:0xf
    v_and_b32_dpp v28, v49, v2 row_newbcast:1 row_mask:0xf bank_mask:0xf
    v_and_b32_dpp v29, v49, v3 row_newbcast:1 row_mask:0xf bank_mask:0xf
    v_and_b32_dpp v30, v49, v4 row_newbcast:1 row_mask:0xf bank_mask:0xf
    v_and_b32_dpp v31, v49, v5 row_newbcast:1 row_mask:0xf bank_mask:0xf
    v_mfma_f32_16x16x32_bf16 v[10:13], v[24:27], v[56:59], 0
    v_and_b32_dpp v24, v49, v2 row_newbcast:2 row_mask:0xf bank_mask:0xf
    v_and_b32_dpp v25, v49, v3 row_newbcast:2 row_mask:0xf bank_mask:0xf
    v_and_b32_dpp v26, v49, v4 row_newbcast:2 row_mask:0xf bank_mask:0xf
    v_and_b32_dpp v27, v49, v5 row_newbcast:2 row_mask:0xf bank_mask:0xf
    v_mfma_f32_16x16x32_bf16 v[10:13], v[28:31], v[60:63], v[10:13]
    v_and_b32_dpp v28, v49, v2 row_newbcast:3 row_mask:0xf bank_mask:0xf
    v_and_b32_dpp v29, v49, v3 row_newbcast:3 row_mask:0xf bank_mask:0xf
    v_and_b32_dpp v30, v49, v4 row_newbcast:3 row_mask:0xf bank_mask:0xf
    v_and_b32_dpp v31, v49, v5 row_newbcast:3 row_mask:0xf bank_mask:0xf
    v_mfma_f32_16x16x32_bf16 v[10:13], v[24:27], v[64:67], v[10:13]
    v_and_b32_dpp v24, v49, v2 row_newbcast:4 row_mask:0xf bank_mask:0xf
    v_and_b32_dpp v25, v49, v3 row_newbcast:4 row_mask:0xf bank_mask:0xf
    v_and_b32_dpp v26, v49, v4 row_newbcast:4 row_mask:0xf bank_mask:0xf
    v_and_b32_dpp v27, v49, v5 row_newbcast:4 row_mask:0xf bank_mask:0xf
    v_mfma_f32_16x16x32_bf16 v[10:13], v[28:31], v[68:71], v[10:13]
    v_and_b32_dpp v28, v49, v2 row_newbcast:5 row_mask:0xf bank_mask:0xf
    v_and_b32_dpp v29, v49, v3 row_newbcast:5 row_mask:0xf bank_mask:0xf
    v_and_b32_dpp v30, v49, v4 row_newbcast:5 row_mask:0xf bank_mask:0xf
    v_and_b32_dpp v31, v49, v5 row_newbcast:5 row_mask:0xf bank_mask:0xf
    v_mfma_f32_16x16x32_bf16 v[10:13], v[24:27], v[72:75], v[10:13]
    v_and_b32_dpp v24, v49, v2 row_newbcast:6 row_mask:0xf bank_mask:0xf
    v_and_b32_dpp v25, v49, v3 row_newbcast:6 row_mask:0xf bank_mask:0xf
    v_and_b32_dpp v26, v49, v4 row_newbcast:6 row_mask:0xf bank_mask:0xf
    v_and_b32_dpp v27, v49, v5 row_newbcast:6 row_mask:0xf bank_mask:0xf
    v_mfma_f32_16x16x32_bf16 v[10:13], v[28:31], v[76:79], v[10:13]
    v_and_b32_dpp v28, v49, v2 row_newbcast:7 row_mask:0xf bank_mask:0xf
    v_and_b32_dpp v29, v49, v3 row_newbcast:7 row_mask:0xf bank_mask:0xf
    v_and_b32_dpp v30, v49, v4 row_newbcast:7 row_mask:0xf bank_mask:0xf
    v_and_b32_dpp v31, v49, v5 row_newbcast:7 row_mask:0xf bank_mask:0xf
    v_mfma_f32_16x16x32_bf16 v[10:13], v[24:27], v[80:83], v[10:13]
    v_and_b32_dpp v24, v49, v2 row_newbcast:8 row_mask:0xf bank_mask:0xf
    v_and_b32_dpp v25, v49, v3 row_newbcast:8 row_mask:0xf bank_mask:0xf
    v_and_b32_dpp v26, v49, v4 row_newbcast:8 row_mask:0xf bank_mask:0xf
    v_and_b32_dpp v27, v49, v5 row_newbcast:8 row_mask:0xf bank_mask:0xf
    v_mfma_f32_16x16x32_bf16 v[10:13], v[28:31], v[84:87], v[10:13]
    v_and_b32_dpp v28, v49, v2 row_newbcast:9 row_mask:0xf bank_mask:0xf
    v_and_b32_dpp v29, v49, v3 row_newbcast:9 row_mask:0xf bank_mask:0xf
    v_and_b32_dpp v30, v49, v4 row_newbcast:9 row_mask:0xf bank_mask:0xf
    v_and_b32_dpp v31, v49, v5 row_newbcast:9 row_mask:0xf bank_mask:0xf
    v_mfma_f32_16x16x32_bf16 v[10:13], v[24:27], v[88:91], v[10:13]
    v_and_b32_dpp v24, v49, v2 row_newbcast:10 row_mask:0xf bank_mask:0xf
    v_and_b32_dpp v25, v49, v3 row_newbcast:10 row_mask:0xf bank_mask:0xf
    v_and_b32_dpp v26, v49, v4 row_newbcast:10 row_mask:0xf bank_mask:0xf
    v_and_b32_dpp v27, v49, v5 row_newbcast:10 row_mask:0xf bank_mask:0xf
    v_mfma_f32_16x16x32_bf16 v[10:13], v[28:31], v[92:95], v[10:13]
    v_and_b32_dpp v28, v49, v2 row_newbcast:11 row_mask:0xf bank_mask:0xf
    v_and_b32_dpp v29, v49, v3 row_newbcast:11 row_mask:0xf bank_mask:0xf
    v_and_b32_dpp v30, v49, v4 row_newbcast:11 row_mask:0xf bank_mask:0xf
    v_and_b32_dpp v31, v49, v5 row_newbcast:11 row_mask:0xf bank_mask:0xf
    v_mfma_f32_16x16x32_bf16 v[10:13], v[24:27], v[96:99], v[10:13]
    v_and_b32_dpp v24, v49, v2 row_newbcast:12 row_mask:0xf bank_mask:0xf
    v_and_b32_dpp v25, v49, v3 row_newbcast:12 row_mask:0xf bank_mask:0xf
    v_and_b32_dpp v26, v49, v4 row_newbcast:12 row_mask:0xf bank_mask:0xf
    v_and_b32_dpp v27, v49, v5 row_newbcast:12 row_mask:0xf bank_mask:0xf
    v_mfma_f32_16x16x32_bf16 v[10:13], v[28:31], v[100:103], v[10:13]
    v_and_b32_dpp v28, v49, v2 row_newbcast:13 row_mask:0xf bank_mask:0xf
    v_and_b32_dpp v29, v49, v3 row_newbcast:13 row_mask:0xf bank_mask:0xf
    v_and_b32_dpp v30, v49, v4 row_newbcast:13 row_mask:0xf bank_mask:0xf
    v_and_b32_dpp v31, v49, v5 row_newbcast:13 row_mask:0xf bank_mask:0xf
    v_mfma_f32_16x16x32_bf16 v[10:13], v[24:27], v[104:107], v[10:13]
    v_and_b32_dpp v24, v49, v2 row_newbcast:14 row_mask:0xf bank_mask:0xf
    v_and_b32_dpp v25, v49, v3 row_newbcast:14 row_mask:0xf bank_mask:0xf
    v_and_b32_dpp v26, v49, v4 row_newbcast:14 row_mask:0xf bank_mask:0xf
    v_and_b32_dpp v27, v49, v5 row_newbcast:14 row_mask:0xf bank_mask:0xf
    v_mfma_f32_16x16x32_bf16 v[10:13], v[28:31], v[108:111], v[10:13]
    v_and_b32_dpp v28, v49, v2 row_newbcast:15 row_mask:0xf bank_mask:0xf
    v_and_b32_dpp v29, v49, v3 row_newbcast:15 row_mask:0xf bank_mask:0xf
    v_and_b32_dpp v30, v49, v4 row_newbcast:15 row_mask:0xf bank_mask:0xf
    v_and_b32_dpp v31, v49, v5 row_newbcast:15 row_mask:0xf bank_mask:0xf
    v_mfma_f32_16x16x32_bf16 v[10:13], v[24:27], v[112:115], v[10:13]
    v_and_b32_dpp v24, v50, v2 row_newbcast:0 row_mask:0xf bank_mask:0xf
    v_and_b32_dpp v25, v50, v3 row_newbcast:0 row_mask:0xf bank_mask:0xf
    v_and_b32_dpp v26, v50, v4 row_newbcast:0 row_mask:0xf bank_mask:0xf
    v_and_b32_dpp v27, v50, v5 row_newbcast:0 row_mask:0xf bank_mask:0xf
    v_mfma_f32_16x16x32_bf16 v[10:13], v[28:31], v[116:119], v[10:13]
    v_and_b32_dpp v28, v50, v2 row_newbcast:1 row_mask:0xf bank_mask:0xf
    v_and_b32_dpp v29, v50, v3 row_newbcast:1 row_mask:0xf bank_mask:0xf
    v_and_b32_dpp v30, v50, v4 row_newbcast:1 row_mask:0xf bank_mask:0xf
    v_and_b32_dpp v31, v50, v5 row_newbcast:1 row_mask:0xf bank_mask:0xf
    v_mfma_f32_16x16x32_bf16 v[10:13], v[24:27], v[120:123], v[10:13]
    s_nop 0
    v_mfma_f32_16x16x32_bf16 v[10:13], v[28:31], v[124:127], v[10:13]
    v_cmp_gt_u32 vcc, 32, v0
    v_mov_b32 v17, v51
    v_mov_b32 v19, v51
    s_lshl_b32 s14, s8, 10
    s_add_u32 s14, s14, 655360
    s_nop 2
    v_cndmask_b32 v16, v12, v10, vcc
    v_cndmask_b32 v18, v13, v11, vcc
    buffer_store_dwordx4 v[16:19], v53, s[56:59], s14 offen sc1
    v_mov_b32 v24, -1
    v_mov_b32 v25, -1
    v_mov_b32 v26, -1
    v_mov_b32 v27, -1
    v_mov_b32 v28, 1536
    s_mul_i32 s14, s8, 640
    s_mov_b32 exec_lo, 0xffffffff
    s_mov_b32 exec_hi, 0x1
    buffer_store_dwordx4 v[24:27], v53, s[56:59], s14 offen sc1
    s_mov_b64 exec, 1
    s_cmp_lg_u32 s4, 0
    s_cbranch_scc1 L_noinit
    s_lshl_b32 s14, s6, 8
    s_add_u32 s14, s14, 917504
    buffer_store_dword v28, v54, s[56:59], s14 offen sc1
L_noinit:
    s_mov_b64 exec, -1
    s_cmp_ge_u32 s5, 27
    s_cbranch_scc1 L_noclr
    s_mul_i32 s14, s4, 2304
    s_lshl_b32 s15, s9, 8
    s_add_u32 s14, s14, s15
    s_add_u32 s14, s14, 163840
    s_cmp_lt_u32 s5, 18
    s_cbranch_scc1 L_norep
    v_lshrrev_b32 v32, 4, v0
    v_mul_u32_u24 v32, 18176, v32
    v_add_u32 v32, v32, v53
    buffer_store_dwordx4 v[24:27], v32, s[56:59], s14 offen sc1
    s_branch L_noclr
L_norep:
    s_cmp_ge_u32 s5, 18
    s_cbranch_scc1 L_clr16
    s_mul_i32 s14, s9, 2304
    s_add_u32 s14, s14, 262144
    buffer_store_dwordx4 v[24:27], v53, s[56:59], s14 offen offset:256 sc1
    buffer_store_dwordx4 v[24:27], v53, s[56:59], s14 offen offset:1280 sc1
L_clr16:
    s_mov_b64 exec, 0xffff
    buffer_store_dwordx4 v[24:27], v53, s[56:59], s14 offen sc1
    s_mov_b64 exec, -1
L_noclr:
    s_lshl_b32 s15, s6, 13
    s_add_u32 s15, s15, 655360
    v_add_u32 v32, s15, v53
    v_and_b32 v33, 15, v0
    v_lshlrev_b32 v33, 4, v33
    v_bfe_u32 v34, v0, 4, 1
    v_lshl_add_u32 v33, v34, 3, v33
    v_lshrrev_b32 v34, 5, v0
    v_lshl_add_u32 v33, v34, 2, v33
    s_mov_b32 s14, 0x40000
    s_barrier
    s_barrier
    buffer_load_dwordx4 v[56:59], v32, s[56:59], 0 offen offset:0 sc1
    buffer_load_dwordx4 v[60:63], v32, s[56:59], 0 offen offset:1024 sc1
    buffer_load_dwordx4 v[64:67], v32, s[56:59], 0 offen offset:2048 sc1
    buffer_load_dwordx4 v[68:71], v32, s[56:59], 0 offen offset:3072 sc1
    buffer_load_dwordx4 v[72:75], v32, s[56:59], s11 offen offset:0 sc1
    buffer_load_dwordx4 v[76:79], v32, s[56:59], s11 offen offset:1024 sc1
    buffer_load_dwordx4 v[80:83], v32, s[56:59], s11 offen offset:2048 sc1
    buffer_load_dwordx4 v[84:87], v32, s[56:59], s11 offen offset:3072 sc1
    s_barrier
    s_branch L_qchk
L_qpoll:
    buffer_load_dwordx4 v[56:59], v32, s[56:59], 0 offen offset:0 sc1
    buffer_load_dwordx4 v[60:63], v32, s[56:59], 0 offen offset:1024 sc1
    buffer_load_dwordx4 v[64:67], v32, s[56:59], 0 offen offset:2048 sc1
    buffer_load_dwordx4 v[68:71], v32, s[56:59], 0 offen offset:3072 sc1
    buffer_load_dwordx4 v[72:75], v32, s[56:59], s11 offen offset:0 sc1
    buffer_load_dwordx4 v[76:79], v32, s[56:59], s11 offen offset:1024 sc1
    buffer_load_dwordx4 v[80:83], v32, s[56:59], s11 offen offset:2048 sc1
    buffer_load_dwordx4 v[84:87], v32, s[56:59], s11 offen offset:3072 sc1
L_qchk:
    s_waitcnt vmcnt(0)
    v_xor_b32 v57, v57, v51
    v_xor_b32 v59, v59, v51
    v_xor_b32 v61, v61, v51
    v_xor_b32 v63, v63, v51
    v_xor_b32 v65, v65, v51
    v_xor_b32 v67, v67, v51
    v_xor_b32 v69, v69, v51
    v_xor_b32 v71, v71, v51
    v_xor_b32 v73, v73, v51
    v_xor_b32 v75, v75, v51
    v_xor_b32 v77, v77, v51
    v_xor_b32 v79, v79, v51
    v_xor_b32 v81, v81, v51
    v_xor_b32 v83, v83, v51
    v_xor_b32 v85, v85, v51
    v_xor_b32 v87, v87, v51
    v_or_b32 v34, v57, v59
    v_or3_b32 v34, v34, v61, v63
    v_or3_b32 v34, v34, v65, v67
    v_or3_b32 v34, v34, v69, v71
    v_or3_b32 v34, v34, v73, v75
    v_or3_b32 v34, v34, v77, v79
    v_or3_b32 v34, v34, v81, v83
    v_or3_b32 v34, v34, v85, v87
    v_cmp_ne_u32 vcc, 0, v34
    s_cbranch_vccz L_qok
    s_sub_u32 s14, s14, 1
    s_cbranch_scc0 L_qpoll
L_qok:
    v_add_f32 v56, v56, v60
    v_add_f32 v64, v64, v68
    v_add_f32 v72, v72, v76
    v_add_f32 v80, v80, v84
    v_add_f32 v56, v56, v64
    v_add_f32 v72, v72, v80
    v_add_f32 v16, v56, v72
    v_add_f32 v58, v58, v62
    v_add_f32 v66, v66, v70
    v_add_f32 v74, v74, v78
    v_add_f32 v82, v82, v86
    v_add_f32 v58, v58, v66
    v_add_f32 v74, v74, v82
    v_add_f32 v17, v58, v74
    v_cvt_pk_bf16_f32 v16, v16, v17
    ds_write_b32 v33, v16
    v_mov_b32 v34, 1
    s_mov_b64 exec, 1
    buffer_atomic_add v34, v54, s[60:63], 0 offen offset:128 sc1
    s_mov_b64 exec, -1
    s_waitcnt lgkmcnt(0)
    s_barrier
    s_setprio 0
L_loads:
    buffer_load_dwordx4 v[120:123], v1, s[40:43], 0 offen offset:0 nt
    buffer_load_dwordx4 v[124:127], v1, s[40:43], 0 offen offset:1024 nt
    buffer_load_dwordx4 v[128:131], v1, s[40:43], 0 offen offset:2048 nt
    buffer_load_dwordx4 v[132:135], v1, s[40:43], 0 offen offset:3072 nt
    buffer_load_dwordx4 v[136:139], v1, s[40:43], s11 offen offset:0 nt
    buffer_load_dwordx4 v[140:143], v1, s[40:43], s11 offen offset:1024 nt
    buffer_load_dwordx4 v[144:147], v1, s[40:43], s11 offen offset:2048 nt
    buffer_load_dwordx4 v[148:151], v1, s[40:43], s11 offen offset:3072 nt
    s_cmp_eq_u32 s3, 0
    s_cbranch_scc1 L_nobar1
    s_barrier
L_nobar1:
    buffer_load_dwordx4 v[152:155], v1, s[44:47], 0 offen offset:0 nt
    buffer_load_dwordx4 v[156:159], v1, s[44:47], 0 offen offset:1024 nt
    buffer_load_dwordx4 v[160:163], v1, s[44:47], 0 offen offset:2048 nt
    buffer_load_dwordx4 v[164:167], v1, s[44:47], 0 offen offset:3072 nt
    buffer_load_dwordx4 v[168:171], v1, s[44:47], s11 offen offset:0 nt
    buffer_load_dwordx4 v[172:175], v1, s[44:47], s11 offen offset:1024 nt
    buffer_load_dwordx4 v[176:179], v1, s[44:47], s11 offen offset:2048 nt
    buffer_load_dwordx4 v[180:183], v1, s[44:47], s11 offen offset:3072 nt
    s_cmp_eq_u32 s3, 0
    s_cbranch_scc1 L_nobar2
    s_barrier
    s_barrier
L_nobar2:
    v_add_u32 v1, 65536, v1
    buffer_load_dwordx4 v[184:187], v1, s[40:43], 0 offen offset:0 nt
    buffer_load_dwordx4 v[188:191], v1, s[40:43], 0 offen offset:1024 nt
    buffer_load_dwordx4 v[192:195], v1, s[40:43], 0 offen offset:2048 nt
    buffer_load_dwordx4 v[196:199], v1, s[40:43], 0 offen offset:3072 nt
    buffer_load_dwordx4 v[200:203], v1, s[40:43], s11 offen offset:0 nt
    buffer_load_dwordx4 v[204:207], v1, s[40:43], s11 offen offset:1024 nt
    buffer_load_dwordx4 v[208:211], v1, s[40:43], s11 offen offset:2048 nt
    buffer_load_dwordx4 v[212:215], v1, s[40:43], s11 offen offset:3072 nt
    buffer_load_dwordx4 v[216:219], v1, s[44:47], 0 offen offset:0 nt
    buffer_load_dwordx4 v[220:223], v1, s[44:47], 0 offen offset:1024 nt
    buffer_load_dwordx4 v[224:227], v1, s[44:47], 0 offen offset:2048 nt
    buffer_load_dwordx4 v[228:231], v1, s[44:47], 0 offen offset:3072 nt
    buffer_load_dwordx4 v[232:235], v1, s[44:47], s11 offen offset:0 nt
    buffer_load_dwordx4 v[236:239], v1, s[44:47], s11 offen offset:1024 nt
    buffer_load_dwordx4 v[240:243], v1, s[44:47], s11 offen offset:2048 nt
    buffer_load_dwordx4 v[244:247], v1, s[44:47], s11 offen offset:3072 nt
    v_add_u32 v1, 65536, v1
    s_add_u32 s14, s7, s3
    s_add_u32 s14, s14, 32
    s_lshl_b32 s14, s14, 12
    v_add_u32 v1, s14, v53
    buffer_load_dwordx4 v[56:59], v1, s[40:43], 0 offen offset:0 nt
    buffer_load_dwordx4 v[60:63], v1, s[40:43], 0 offen offset:1024 nt
    buffer_load_dwordx4 v[64:67], v1, s[40:43], 0 offen offset:2048 nt
    buffer_load_dwordx4 v[68:71], v1, s[40:43], 0 offen offset:3072 nt
    buffer_load_dwordx4 v[88:91], v1, s[44:47], 0 offen offset:0 nt
    buffer_load_dwordx4 v[92:95], v1, s[44:47], 0 offen offset:1024 nt
    buffer_load_dwordx4 v[96:99], v1, s[44:47], 0 offen offset:2048 nt
    buffer_load_dwordx4 v[100:103], v1, s[44:47], 0 offen offset:3072 nt
    v_and_b32 v32, 1, v0
    v_lshlrev_b32 v32, 4, v32
    v_mov_b32 v33, 0xffff
    v_lshlrev_b32 v32, v32, v33
    v_bfe_u32 v33, v0, 1, 2
    v_cmp_eq_u32 vcc, 0, v33
    s_nop 1
    v_cndmask_b32 v2, 0, v32, vcc
    v_cmp_eq_u32 vcc, 1, v33
    s_nop 1
    v_cndmask_b32 v3, 0, v32, vcc
    v_cmp_eq_u32 vcc, 2, v33
    s_nop 1
    v_cndmask_b32 v4, 0, v32, vcc
    v_cmp_eq_u32 vcc, 3, v33
    s_nop 1
    v_cndmask_b32 v5, 0, v32, vcc
    v_and_b32 v104, 15, v0
    v_lshlrev_b32 v104, 5, v104
    v_and_b32 v105, 16, v0
    s_mul_i32 s14, s3, 528
    v_add3_u32 v105, v104, v105, s14
    v_lshrrev_b32 v106, 4, v0
    v_lshl_add_u32 v106, v106, 2, s14
    s_lshl_b32 s14, s3, 2
    v_mov_b32 v107, s14
    v_and_b32 v32, 8, v0
    v_cmp_eq_u32 vcc, 0, v32
    v_mov_b32 v32, 0x03020302
    v_mov_b32 v33, 0x01000100
    v_cndmask_b32 v32, v32, v33, vcc
    v_mov_b32 v33, 0x0c0c0c0c
    v_bfi_b32 v36, v2, v32, v33
    v_bfi_b32 v37, v3, v32, v33
    v_bfi_b32 v38, v4, v32, v33
    v_bfi_b32 v39, v5, v32, v33
    v_mov_b32 v55, 0xff800000
    v_mov_b32 v14, 0
    v_mov_b32 v15, 0
    v_mov_b32 v51, 1
    v_and_b32 v32, 15, v0
    v_lshlrev_b32 v32, 4, v32
    s_lshl_b32 s88, s6, 8
    s_add_u32 s88, s88, 917504
    s_mov_b32 s87, 0
    v_mov_b32 v10, 0
    v_mov_b32 v11, 0
    v_mov_b32 v12, 0
    v_mov_b32 v13, 0
    s_cmp_eq_u32 s3, 0
    s_cbranch_scc1 L_nobar
    s_barrier
L_nobar:
    ds_read_b128 v[6:9], v32
    s_add_u32 s14, s7, s3
    s_add_u32 s14, s14, 40
    v_mov_b32 v52, s14
    s_waitcnt lgkmcnt(0)
    s_mul_i32 s90, s3, 0
    s_add_u32 s90, s90, 48
    s_waitcnt vmcnt(32)
    v_dot2_f32_bf16 v16, v120, v6, 0
    v_dot2_f32_bf16 v17, v124, v6, 0
    v_dot2_f32_bf16 v18, v128, v6, 0
    v_dot2_f32_bf16 v19, v132, v6, 0
    v_dot2_f32_bf16 v20, v136, v6, 0
    v_dot2_f32_bf16 v21, v140, v6, 0
    v_dot2_f32_bf16 v22, v144, v6, 0
    v_dot2_f32_bf16 v23, v148, v6, 0
    v_dot2_f32_bf16 v16, v121, v7, v16
    v_dot2_f32_bf16 v17, v125, v7, v17
    v_dot2_f32_bf16 v18, v129, v7, v18
    v_dot2_f32_bf16 v19, v133, v7, v19
    v_dot2_f32_bf16 v20, v137, v7, v20
    v_dot2_f32_bf16 v21, v141, v7, v21
    v_dot2_f32_bf16 v22, v145, v7, v22
    v_dot2_f32_bf16 v23, v149, v7, v23
    v_dot2_f32_bf16 v16, v122, v8, v16
    v_dot2_f32_bf16 v17, v126, v8, v17
    v_dot2_f32_bf16 v18, v130, v8, v18
    v_dot2_f32_bf16 v19, v134, v8, v19
    v_dot2_f32_bf16 v20, v138, v8, v20
    v_dot2_f32_bf16 v21, v142, v8, v21
    v_dot2_f32_bf16 v22, v146, v8, v22
    v_dot2_f32_bf16 v23, v150, v8, v23
    v_dot2_f32_bf16 v16, v123, v9, v16
    v_dot2_f32_bf16 v17, v127, v9, v17
    v_dot2_f32_bf16 v18, v131, v9, v18
    v_dot2_f32_bf16 v19, v135, v9, v19
    v_dot2_f32_bf16 v20, v139, v9, v20
    v_dot2_f32_bf16 v21, v143, v9, v21
    v_dot2_f32_bf16 v22, v147, v9, v22
    v_dot2_f32_bf16 v23, v151, v9, v23
    v_add_f32_dpp v16, v16, v16 row_ror:8 row_mask:0xf bank_mask:0x3
    v_add_f32_dpp v17, v17, v17 row_ror:8 row_mask:0xf bank_mask:0x3
    v_add_f32_dpp v18, v18, v18 row_ror:8 row_mask:0xf bank_mask:0x3
    v_add_f32_dpp v19, v19, v19 row_ror:8 row_mask:0xf bank_mask:0x3
    v_add_f32_dpp v16, v20, v20 row_ror:8 row_mask:0xf bank_mask:0xc
    v_add_f32_dpp v17, v21, v21 row_ror:8 row_mask:0xf bank_mask:0xc
    v_add_f32_dpp v18, v22, v22 row_ror:8 row_mask:0xf bank_mask:0xc
    v_add_f32_dpp v19, v23, v23 row_ror:8 row_mask:0xf bank_mask:0xc
    v_add_f32_dpp v16, v16, v16 row_half_mirror row_mask:0xf bank_mask:0x5
    v_add_f32_dpp v17, v17, v17 row_half_mirror row_mask:0xf bank_mask:0x5
    s_nop 0
    v_add_f32_dpp v16, v18, v18 row_half_mirror row_mask:0xf bank_mask:0xa
    v_add_f32_dpp v17, v19, v19 row_half_mirror row_mask:0xf bank_mask:0xa
    s_nop 0
    v_add_f32_dpp v16, v16, v16 quad_perm:[1,0,3,2] row_mask:0xf bank_mask:0xf
    v_add_f32_dpp v17, v17, v17 quad_perm:[1,0,3,2] row_mask:0xf bank_mask:0xf
    v_cndmask_b32 v16, v16, v17, s[12:13]
    s_nop 1
    v_add_f32_dpp v16, v16, v16 quad_perm:[2,3,0,1] row_mask:0xf bank_mask:0xf
    v_cvt_pk_bf16_f32 v16, v16, v16
    v_and_b32 v16, 0xffff0000, v16
    v_mul_f32 v16, 0x3db504f3, v16
    v_cvt_pk_bf16_f32 v16, v16, v16
    v_and_b32 v16, 0xffff0000, v16
    v_cmp_gt_f32 vcc, v16, v55
    s_cbranch_vccnz L_slow1
L_back1:
    v_sub_f32 v16, v16, v55
    v_mul_f32 v16, 0x3fb8aa3b, v16
    v_exp_f32 v16, v16
    s_nop 0
    v_fmac_f32 v14, 0x3f000000, v16
    v_cvt_pk_bf16_f32 v17, v16, v16
    v_and_b32 v17, 0xffff0000, v17
    v_sub_f32 v16, v16, v17
    v_cvt_pk_bf16_f32 v33, v17, v16
    s_nop 1
    v_mov_b32_dpp v16, v33 row_newbcast:0 row_mask:0xf bank_mask:0xf
    v_mov_b32_dpp v17, v33 row_newbcast:1 row_mask:0xf bank_mask:0xf
    v_mov_b32_dpp v18, v33 row_newbcast:4 row_mask:0xf bank_mask:0xf
    v_mov_b32_dpp v19, v33 row_newbcast:5 row_mask:0xf bank_mask:0xf
    v_mov_b32_dpp v20, v33 row_newbcast:8 row_mask:0xf bank_mask:0xf
    v_mov_b32_dpp v21, v33 row_newbcast:9 row_mask:0xf bank_mask:0xf
    v_mov_b32_dpp v22, v33 row_newbcast:12 row_mask:0xf bank_mask:0xf
    v_mov_b32_dpp v23, v33 row_newbcast:13 row_mask:0xf bank_mask:0xf
    s_waitcnt vmcnt(24)
    v_perm_b32 v24, v16, v16, v36
    v_perm_b32 v25, v16, v16, v37
    v_perm_b32 v26, v16, v16, v38
    v_perm_b32 v27, v16, v16, v39
    v_perm_b32 v28, v17, v17, v36
    v_perm_b32 v29, v17, v17, v37
    v_perm_b32 v30, v17, v17, v38
    v_perm_b32 v31, v17, v17, v39
    v_mfma_f32_16x16x32_bf16 v[10:13], v[24:27], v[152:155], v[10:13]
    v_perm_b32 v24, v18, v18, v36
    v_perm_b32 v25, v18, v18, v37
    v_perm_b32 v26, v18, v18, v38
    v_perm_b32 v27, v18, v18, v39
    v_mfma_f32_16x16x32_bf16 v[10:13], v[28:31], v[156:159], v[10:13]
    v_perm_b32 v28, v19, v19, v36
    v_perm_b32 v29, v19, v19, v37
    v_perm_b32 v30, v19, v19, v38
    v_perm_b32 v31, v19, v19, v39
    v_mfma_f32_16x16x32_bf16 v[10:13], v[24:27], v[160:163], v[10:13]
    v_perm_b32 v24, v20, v20, v36
    v_perm_b32 v25, v20, v20, v37
    v_perm_b32 v26, v20, v20, v38
    v_perm_b32 v27, v20, v20, v39
    v_mfma_f32_16x16x32_bf16 v[10:13], v[28:31], v[164:167], v[10:13]
    v_perm_b32 v28, v21, v21, v36
    v_perm_b32 v29, v21, v21, v37
    v_perm_b32 v30, v21, v21, v38
    v_perm_b32 v31, v21, v21, v39
    v_mfma_f32_16x16x32_bf16 v[10:13], v[24:27], v[168:171], v[10:13]
    v_perm_b32 v24, v22, v22, v36
    v_perm_b32 v25, v22, v22, v37
    v_perm_b32 v26, v22, v22, v38
    v_perm_b32 v27, v22, v22, v39
    v_mfma_f32_16x16x32_bf16 v[10:13], v[28:31], v[172:175], v[10:13]
    v_perm_b32 v28, v23, v23, v36
    v_perm_b32 v29, v23, v23, v37
    v_perm_b32 v30, v23, v23, v38
    v_perm_b32 v31, v23, v23, v39
    v_mfma_f32_16x16x32_bf16 v[10:13], v[24:27], v[176:179], v[10:13]
    s_nop 0
    v_mfma_f32_16x16x32_bf16 v[10:13], v[28:31], v[180:183], v[10:13]
    s_waitcnt vmcnt(16)
    v_dot2_f32_bf16 v16, v184, v6, 0
    v_dot2_f32_bf16 v17, v188, v6, 0
    v_dot2_f32_bf16 v18, v192, v6, 0
    v_dot2_f32_bf16 v19, v196, v6, 0
    v_dot2_f32_bf16 v20, v200, v6, 0
    v_dot2_f32_bf16 v21, v204, v6, 0
    v_dot2_f32_bf16 v22, v208, v6, 0
    v_dot2_f32_bf16 v23, v212, v6, 0
    v_dot2_f32_bf16 v16, v185, v7, v16
    v_dot2_f32_bf16 v17, v189, v7, v17
    v_dot2_f32_bf16 v18, v193, v7, v18
    v_dot2_f32_bf16 v19, v197, v7, v19
    v_dot2_f32_bf16 v20, v201, v7, v20
    v_dot2_f32_bf16 v21, v205, v7, v21
    v_dot2_f32_bf16 v22, v209, v7, v22
    v_dot2_f32_bf16 v23, v213, v7, v23
    v_dot2_f32_bf16 v16, v186, v8, v16
    v_dot2_f32_bf16 v17, v190, v8, v17
    v_dot2_f32_bf16 v18, v194, v8, v18
    v_dot2_f32_bf16 v19, v198, v8, v19
    v_dot2_f32_bf16 v20, v202, v8, v20
    v_dot2_f32_bf16 v21, v206, v8, v21
    v_dot2_f32_bf16 v22, v210, v8, v22
    v_dot2_f32_bf16 v23, v214, v8, v23
    v_dot2_f32_bf16 v16, v187, v9, v16
    v_dot2_f32_bf16 v17, v191, v9, v17
    v_dot2_f32_bf16 v18, v195, v9, v18
    v_dot2_f32_bf16 v19, v199, v9, v19
    v_dot2_f32_bf16 v20, v203, v9, v20
    v_dot2_f32_bf16 v21, v207, v9, v21
    v_dot2_f32_bf16 v22, v211, v9, v22
    v_dot2_f32_bf16 v23, v215, v9, v23
    v_add_f32_dpp v16, v16, v16 row_ror:8 row_mask:0xf bank_mask:0x3
    v_add_f32_dpp v17, v17, v17 row_ror:8 row_mask:0xf bank_mask:0x3
    v_add_f32_dpp v18, v18, v18 row_ror:8 row_mask:0xf bank_mask:0x3
    v_add_f32_dpp v19, v19, v19 row_ror:8 row_mask:0xf bank_mask:0x3
    v_add_f32_dpp v16, v20, v20 row_ror:8 row_mask:0xf bank_mask:0xc
    v_add_f32_dpp v17, v21, v21 row_ror:8 row_mask:0xf bank_mask:0xc
    v_add_f32_dpp v18, v22, v22 row_ror:8 row_mask:0xf bank_mask:0xc
    v_add_f32_dpp v19, v23, v23 row_ror:8 row_mask:0xf bank_mask:0xc
    v_add_f32_dpp v16, v16, v16 row_half_mirror row_mask:0xf bank_mask:0x5
    v_add_f32_dpp v17, v17, v17 row_half_mirror row_mask:0xf bank_mask:0x5
    s_nop 0
    v_add_f32_dpp v16, v18, v18 row_half_mirror row_mask:0xf bank_mask:0xa
    v_add_f32_dpp v17, v19, v19 row_half_mirror row_mask:0xf bank_mask:0xa
    s_nop 0
    v_add_f32_dpp v16, v16, v16 quad_perm:[1,0,3,2] row_mask:0xf bank_mask:0xf
    v_add_f32_dpp v17, v17, v17 quad_perm:[1,0,3,2] row_mask:0xf bank_mask:0xf
    v_cndmask_b32 v16, v16, v17, s[12:13]
    s_nop 1
    v_add_f32_dpp v16, v16, v16 quad_perm:[2,3,0,1] row_mask:0xf bank_mask:0xf
    v_cvt_pk_bf16_f32 v16, v16, v16
    v_and_b32 v16, 0xffff0000, v16
    v_mul_f32 v16, 0x3db504f3, v16
    v_cvt_pk_bf16_f32 v16, v16, v16
    v_and_b32 v16, 0xffff0000, v16
    v_cmp_gt_f32 vcc, v16, v55
    s_cbranch_vccnz L_slow2
L_back2:
    v_sub_f32 v16, v16, v55
    v_mul_f32 v16, 0x3fb8aa3b, v16
    v_exp_f32 v16, v16
    s_nop 0
    v_fmac_f32 v14, 0x3f000000, v16
    v_cvt_pk_bf16_f32 v17, v16, v16
    v_and_b32 v17, 0xffff0000, v17
    v_sub_f32 v16, v16, v17
    v_cvt_pk_bf16_f32 v33, v17, v16
    s_nop 1
    v_mov_b32_dpp v16, v33 row_newbcast:0 row_mask:0xf bank_mask:0xf
    v_mov_b32_dpp v17, v33 row_newbcast:1 row_mask:0xf bank_mask:0xf
    v_mov_b32_dpp v18, v33 row_newbcast:4 row_mask:0xf bank_mask:0xf
    v_mov_b32_dpp v19, v33 row_newbcast:5 row_mask:0xf bank_mask:0xf
    v_mov_b32_dpp v20, v33 row_newbcast:8 row_mask:0xf bank_mask:0xf
    v_mov_b32_dpp v21, v33 row_newbcast:9 row_mask:0xf bank_mask:0xf
    v_mov_b32_dpp v22, v33 row_newbcast:12 row_mask:0xf bank_mask:0xf
    v_mov_b32_dpp v23, v33 row_newbcast:13 row_mask:0xf bank_mask:0xf
    s_waitcnt vmcnt(8)
    v_perm_b32 v24, v16, v16, v36
    v_perm_b32 v25, v16, v16, v37
    v_perm_b32 v26, v16, v16, v38
    v_perm_b32 v27, v16, v16, v39
    v_perm_b32 v28, v17, v17, v36
    v_perm_b32 v29, v17, v17, v37
    v_perm_b32 v30, v17, v17, v38
    v_perm_b32 v31, v17, v17, v39
    v_mfma_f32_16x16x32_bf16 v[10:13], v[24:27], v[216:219], v[10:13]
    v_perm_b32 v24, v18, v18, v36
    v_perm_b32 v25, v18, v18, v37
    v_perm_b32 v26, v18, v18, v38
    v_perm_b32 v27, v18, v18, v39
    v_mfma_f32_16x16x32_bf16 v[10:13], v[28:31], v[220:223], v[10:13]
    v_perm_b32 v28, v19, v19, v36
    v_perm_b32 v29, v19, v19, v37
    v_perm_b32 v30, v19, v19, v38
    v_perm_b32 v31, v19, v19, v39
    v_mfma_f32_16x16x32_bf16 v[10:13], v[24:27], v[224:227], v[10:13]
    v_perm_b32 v24, v20, v20, v36
    v_perm_b32 v25, v20, v20, v37
    v_perm_b32 v26, v20, v20, v38
    v_perm_b32 v27, v20, v20, v39
    v_mfma_f32_16x16x32_bf16 v[10:13], v[28:31], v[228:231], v[10:13]
    v_perm_b32 v28, v21, v21, v36
    v_perm_b32 v29, v21, v21, v37
    v_perm_b32 v30, v21, v21, v38
    v_perm_b32 v31, v21, v21, v39
    v_mfma_f32_16x16x32_bf16 v[10:13], v[24:27], v[232:235], v[10:13]
    v_perm_b32 v24, v22, v22, v36
    v_perm_b32 v25, v22, v22, v37
    v_perm_b32 v26, v22, v22, v38
    v_perm_b32 v27, v22, v22, v39
    v_mfma_f32_16x16x32_bf16 v[10:13], v[28:31], v[236:239], v[10:13]
    v_perm_b32 v28, v23, v23, v36
    v_perm_b32 v29, v23, v23, v37
    v_perm_b32 v30, v23, v23, v38
    v_perm_b32 v31, v23, v23, v39
    v_mfma_f32_16x16x32_bf16 v[10:13], v[24:27], v[240:243], v[10:13]
    s_nop 0
    v_mfma_f32_16x16x32_bf16 v[10:13], v[28:31], v[244:247], v[10:13]
L_loop:
    s_mov_b64 exec, 1
    ds_add_rtn_u32 v32, v54, v51 offset:8512
    s_mov_b64 exec, -1
    s_waitcnt vmcnt(4)
    v_readfirstlane_b32 s80, v52
    v_dot2_f32_bf16 v16, v56, v6, 0
    v_dot2_f32_bf16 v17, v60, v6, 0
    v_dot2_f32_bf16 v18, v64, v6, 0
    v_dot2_f32_bf16 v19, v68, v6, 0
    v_dot2_f32_bf16 v16, v57, v7, v16
    v_dot2_f32_bf16 v17, v61, v7, v17
    v_dot2_f32_bf16 v18, v65, v7, v18
    v_dot2_f32_bf16 v19, v69, v7, v19
    v_dot2_f32_bf16 v16, v58, v8, v16
    v_dot2_f32_bf16 v17, v62, v8, v17
    v_dot2_f32_bf16 v18, v66, v8, v18
    v_dot2_f32_bf16 v19, v70, v8, v19
    v_dot2_f32_bf16 v16, v59, v9, v16
    v_dot2_f32_bf16 v17, v63, v9, v17
    v_dot2_f32_bf16 v18, v67, v9, v18
    v_dot2_f32_bf16 v19, v71, v9, v19
    s_cmp_ge_u32 s80, 2048
    s_cbranch_scc1 L_last
    s_lshl_b32 s14, s80, 12
    v_add_u32 v1, s14, v53
    buffer_load_dwordx4 v[56:59], v1, s[40:43], 0 offen offset:0 nt
    buffer_load_dwordx4 v[60:63], v1, s[40:43], 0 offen offset:1024 nt
    buffer_load_dwordx4 v[64:67], v1, s[40:43], 0 offen offset:2048 nt
    buffer_load_dwordx4 v[68:71], v1, s[40:43], 0 offen offset:3072 nt
    s_waitcnt lgkmcnt(0)
    v_readfirstlane_b32 s81, v32
    s_mov_b64 exec, 1
    s_cmp_ge_u32 s81, 192
    s_cbranch_scc1 L_dyn
    v_add_u32 v52, s7, v32
    buffer_load_dword v15, v54, s[60:63], 0 offen offset:128 sc1
L_dynback:
    s_mov_b64 exec, -1
    v_add_f32_dpp v16, v16, v16 row_ror:8 row_mask:0xf bank_mask:0x3
    v_add_f32_dpp v17, v17, v17 row_ror:8 row_mask:0xf bank_mask:0x3
    s_nop 0
    v_add_f32_dpp v16, v18, v18 row_ror:8 row_mask:0xf bank_mask:0xc
    v_add_f32_dpp v17, v19, v19 row_ror:8 row_mask:0xf bank_mask:0xc
    s_nop 0
    v_add_f32_dpp v16, v16, v16 row_half_mirror row_mask:0xf bank_mask:0x5
    s_nop 1
    v_add_f32_dpp v16, v17, v17 row_half_mirror row_mask:0xf bank_mask:0xa
    s_nop 1
    v_add_f32_dpp v16, v16, v16 quad_perm:[1,0,3,2] row_mask:0xf bank_mask:0xf
    s_nop 1
    v_add_f32_dpp v16, v16, v16 quad_perm:[2,3,0,1] row_mask:0xf bank_mask:0xf
    v_cvt_pk_bf16_f32 v16, v16, v16
    v_and_b32 v16, 0xffff0000, v16
    v_mul_f32 v16, 0x3db504f3, v16
    v_cvt_pk_bf16_f32 v16, v16, v16
    v_and_b32 v16, 0xffff0000, v16
    v_cmp_gt_f32 vcc, v16, v55
    s_cbranch_vccnz L_slow0
L_back0:
    v_sub_f32 v16, v16, v55
    v_mul_f32 v16, 0x3fb8aa3b, v16
    v_exp_f32 v16, v16
    s_nop 0
    v_fmac_f32 v14, 0x3e800000, v16
    v_cvt_pk_bf16_f32 v17, v16, v16
    v_and_b32 v17, 0xffff0000, v17
    v_sub_f32 v16, v16, v17
    v_cvt_pk_bf16_f32 v33, v17, v16
    s_nop 1
    v_mov_b32_dpp v16, v33 row_newbcast:0 row_mask:0xf bank_mask:0xf
    v_mov_b32_dpp v17, v33 row_newbcast:4 row_mask:0xf bank_mask:0xf
    v_mov_b32_dpp v18, v33 row_newbcast:8 row_mask:0xf bank_mask:0xf
    v_mov_b32_dpp v19, v33 row_newbcast:12 row_mask:0xf bank_mask:0xf
    s_waitcnt vmcnt(5)
    v_perm_b32 v24, v16, v16, v36
    v_perm_b32 v25, v16, v16, v37
    v_perm_b32 v26, v16, v16, v38
    v_perm_b32 v27, v16, v16, v39
    v_perm_b32 v28, v17, v17, v36
    v_perm_b32 v29, v17, v17, v37
    v_perm_b32 v30, v17, v17, v38
    v_perm_b32 v31, v17, v17, v39
    v_mfma_f32_16x16x32_bf16 v[10:13], v[24:27], v[88:91], v[10:13]
    v_perm_b32 v24, v18, v18, v36
    v_perm_b32 v25, v18, v18, v37
    v_perm_b32 v26, v18, v18, v38
    v_perm_b32 v27, v18, v18, v39
    v_mfma_f32_16x16x32_bf16 v[10:13], v[28:31], v[92:95], v[10:13]
    v_perm_b32 v28, v19, v19, v36
    v_perm_b32 v29, v19, v19, v37
    v_perm_b32 v30, v19, v19, v38
    v_perm_b32 v31, v19, v19, v39
    v_mfma_f32_16x16x32_bf16 v[10:13], v[24:27], v[96:99], v[10:13]
    s_nop 0
    v_mfma_f32_16x16x32_bf16 v[10:13], v[28:31], v[100:103], v[10:13]
    buffer_load_dwordx4 v[88:91], v1, s[44:47], 0 offen offset:0 nt
    buffer_load_dwordx4 v[92:95], v1, s[44:47], 0 offen offset:1024 nt
    buffer_load_dwordx4 v[96:99], v1, s[44:47], 0 offen offset:2048 nt
    buffer_load_dwordx4 v[100:103], v1, s[44:47], 0 offen offset:3072 nt
    s_cmp_ge_u32 s81, s90
    s_cbranch_scc1 L_wload
L_wdone:
    s_branch L_loop
L_last:
    s_nop 1
    v_add_f32_dpp v16, v16, v16 row_ror:8 row_mask:0xf bank_mask:0x3
    v_add_f32_dpp v17, v17, v17 row_ror:8 row_mask:0xf bank_mask:0x3
    s_nop 0
    v_add_f32_dpp v16, v18, v18 row_ror:8 row_mask:0xf bank_mask:0xc
    v_add_f32_dpp v17, v19, v19 row_ror:8 row_mask:0xf bank_mask:0xc
    s_nop 0
    v_add_f32_dpp v16, v16, v16 row_half_mirror row_mask:0xf bank_mask:0x5
    s_nop 1
    v_add_f32_dpp v16, v17, v17 row_half_mirror row_mask:0xf bank_mask:0xa
    s_nop 1
    v_add_f32_dpp v16, v16, v16 quad_perm:[1,0,3,2] row_mask:0xf bank_mask:0xf
    s_nop 1
    v_add_f32_dpp v16, v16, v16 quad_perm:[2,3,0,1] row_mask:0xf bank_mask:0xf
    v_cvt_pk_bf16_f32 v16, v16, v16
    v_and_b32 v16, 0xffff0000, v16
    v_mul_f32 v16, 0x3db504f3, v16
    v_cvt_pk_bf16_f32 v16, v16, v16
    v_and_b32 v16, 0xffff0000, v16
    v_cmp_gt_f32 vcc, v16, v55
    s_cbranch_vccnz L_slow9
L_back9:
    v_sub_f32 v16, v16, v55
    v_mul_f32 v16, 0x3fb8aa3b, v16
    v_exp_f32 v16, v16
    s_nop 0
    v_fmac_f32 v14, 0x3e800000, v16
    v_cvt_pk_bf16_f32 v17, v16, v16
    v_and_b32 v17, 0xffff0000, v17
    v_sub_f32 v16, v16, v17
    v_cvt_pk_bf16_f32 v33, v17, v16
    s_nop 1
    v_mov_b32_dpp v16, v33 row_newbcast:0 row_mask:0xf bank_mask:0xf
    v_mov_b32_dpp v17, v33 row_newbcast:4 row_mask:0xf bank_mask:0xf
    v_mov_b32_dpp v18, v33 row_newbcast:8 row_mask:0xf bank_mask:0xf
    v_mov_b32_dpp v19, v33 row_newbcast:12 row_mask:0xf bank_mask:0xf
    s_cmp_ge_u32 s5, 18
    s_cbranch_scc1 L_wo_b
    s_waitcnt vmcnt(0)
    s_branch L_wl
L_wo_b:
    s_cmp_ge_u32 s5, 27
    s_cbranch_scc1 L_wz_b
    s_mov_b32 s64, s24
    s_mov_b32 s65, s25
    s_mov_b32 s66, 0x480000
    s_mov_b32 s67, 0x20000
    v_lshrrev_b32 v32, 3, v0
    s_lshl_b32 s14, s4, 3
    s_add_u32 s14, s14, s3
    s_mul_i32 s14, s14, 73728
    s_lshl_b32 s15, s9, 7
    s_add_u32 s14, s14, s15
    v_and_b32 v34, 7, v0
    v_lshlrev_b32 v34, 4, v34
    v_add_u32 v34, s14, v34
    s_movk_i32 s15, 9216
    v_mad_u32_u24 v34, v32, s15, v34
    s_movk_i32 s14, 0
    buffer_load_dwordx4 v[184:187], v34, s[64:67], s14 offen nt
    s_movk_i32 s14, 1152
    buffer_load_dwordx4 v[188:191], v34, s[64:67], s14 offen nt
    s_movk_i32 s14, 2304
    buffer_load_dwordx4 v[192:195], v34, s[64:67], s14 offen nt
    s_movk_i32 s14, 3456
    buffer_load_dwordx4 v[196:199], v34, s[64:67], s14 offen nt
    s_movk_i32 s14, 4608
    buffer_load_dwordx4 v[200:203], v34, s[64:67], s14 offen nt
    s_movk_i32 s14, 5760
    buffer_load_dwordx4 v[204:207], v34, s[64:67], s14 offen nt
    s_movk_i32 s14, 6912
    buffer_load_dwordx4 v[208:211], v34, s[64:67], s14 offen nt
    s_movk_i32 s14, 8064
    buffer_load_dwordx4 v[212:215], v34, s[64:67], s14 offen nt
    s_waitcnt vmcnt(8)
    s_branch L_wl
L_wz_b:
    s_waitcnt vmcnt(0)
    s_branch L_wl
L_wl:
    v_perm_b32 v24, v16, v16, v36
    v_perm_b32 v25, v16, v16, v37
    v_perm_b32 v26, v16, v16, v38
    v_perm_b32 v27, v16, v16, v39
    v_perm_b32 v28, v17, v17, v36
    v_perm_b32 v29, v17, v17, v37
    v_perm_b32 v30, v17, v17, v38
    v_perm_b32 v31, v17, v17, v39
    v_mfma_f32_16x16x32_bf16 v[10:13], v[24:27], v[88:91], v[10:13]
    v_perm_b32 v24, v18, v18, v36
    v_perm_b32 v25, v18, v18, v37
    v_perm_b32 v26, v18, v18, v38
    v_perm_b32 v27, v18, v18, v39
    v_mfma_f32_16x16x32_bf16 v[10:13], v[28:31], v[92:95], v[10:13]
    v_perm_b32 v28, v19, v19, v36
    v_perm_b32 v29, v19, v19, v37
    v_perm_b32 v30, v19, v19, v38
    v_perm_b32 v31, v19, v19, v39
    v_mfma_f32_16x16x32_bf16 v[10:13], v[24:27], v[96:99], v[10:13]
    s_nop 0
    v_mfma_f32_16x16x32_bf16 v[10:13], v[28:31], v[100:103], v[10:13]
    s_nop 7
    v_mov_b32 v16, v10
    v_mov_b32 v17, v11
    v_mov_b32 v18, v12
    v_mov_b32 v19, v13
    v_permlane32_swap_b32 v16, v10
    v_permlane32_swap_b32 v17, v11
    v_permlane32_swap_b32 v18, v12
    v_permlane32_swap_b32 v19, v13
    v_add_f32 v10, v16, v10
    v_add_f32 v11, v17, v11
    v_add_f32 v12, v18, v12
    v_add_f32 v13, v19, v13
    v_add_f32_dpp v14, v14, v14 quad_perm:[1,0,3,2] row_mask:0xf bank_mask:0xf
    s_nop 1
    v_add_f32_dpp v14, v14, v14 quad_perm:[2,3,0,1] row_mask:0xf bank_mask:0xf
    s_nop 1
    v_add_f32_dpp v14, v14, v14 row_half_mirror row_mask:0xf bank_mask:0xf
    s_nop 1
    v_add_f32_dpp v14, v14, v14 row_ror:8 row_mask:0xf bank_mask:0xf
    ds_write_b32 v106, v14 offset:4608
    ds_write_b32 v107, v55 offset:8448
    s_mov_b32 exec_hi, 0
    ds_write_b128 v105, v[10:13] offset:4096
    s_mov_b64 exec, -1
    v_min_u32 v32, 32, v0
    v_lshlrev_b32 v32, 4, v32
    s_mov_b32 s92, 0x3fb8aa3b
    s_waitcnt lgkmcnt(0)
    s_barrier
    s_cmp_lg_u32 s3, 0
    s_cbranch_scc1 L_role2
    ds_read_b128 v[16:19], v54 offset:8448
    ds_read_b128 v[20:23], v54 offset:8464
    ds_read_b128 v[56:59], v32 offset:4096
    ds_read_b128 v[60:63], v32 offset:4624
    ds_read_b128 v[64:67], v32 offset:5152
    ds_read_b128 v[68:71], v32 offset:5680
    ds_read_b128 v[72:75], v32 offset:6208
    ds_read_b128 v[76:79], v32 offset:6736
    ds_read_b128 v[80:83], v32 offset:7264
    ds_read_b128 v[84:87], v32 offset:7792
    s_waitcnt lgkmcnt(8)
    v_max3_f32 v55, v16, v17, v18
    v_max3_f32 v33, v19, v20, v21
    v_max3_f32 v55, v55, v22, v23
    v_max_f32 v55, v55, v33
    v_pk_add_f32 v[16:17], v[16:17], v[54:55] op_sel:[0,1] op_sel_hi:[1,1] neg_lo:[0,1] neg_hi:[0,1]
    v_pk_add_f32 v[18:19], v[18:19], v[54:55] op_sel:[0,1] op_sel_hi:[1,1] neg_lo:[0,1] neg_hi:[0,1]
    v_pk_add_f32 v[20:21], v[20:21], v[54:55] op_sel:[0,1] op_sel_hi:[1,1] neg_lo:[0,1] neg_hi:[0,1]
    v_pk_add_f32 v[22:23], v[22:23], v[54:55] op_sel:[0,1] op_sel_hi:[1,1] neg_lo:[0,1] neg_hi:[0,1]
    v_pk_mul_f32 v[16:17], v[16:17], s[92:93] op_sel_hi:[1,0]
    v_pk_mul_f32 v[18:19], v[18:19], s[92:93] op_sel_hi:[1,0]
    v_pk_mul_f32 v[20:21], v[20:21], s[92:93] op_sel_hi:[1,0]
    v_pk_mul_f32 v[22:23], v[22:23], s[92:93] op_sel_hi:[1,0]
    v_exp_f32 v16, v16
    v_exp_f32 v17, v17
    v_exp_f32 v18, v18
    v_exp_f32 v19, v19
    v_exp_f32 v20, v20
    v_exp_f32 v21, v21
    v_exp_f32 v22, v22
    v_exp_f32 v23, v23
    s_waitcnt lgkmcnt(0)
    v_pk_mul_f32 v[10:11], v[56:57], v[16:17] op_sel_hi:[1,0]
    v_pk_mul_f32 v[12:13], v[58:59], v[16:17] op_sel_hi:[1,0]
    v_pk_fma_f32 v[10:11], v[60:61], v[16:17], v[10:11] op_sel:[0,1,0] op_sel_hi:[1,1,1]
    v_pk_fma_f32 v[12:13], v[62:63], v[16:17], v[12:13] op_sel:[0,1,0] op_sel_hi:[1,1,1]
    v_pk_fma_f32 v[10:11], v[64:65], v[18:19], v[10:11] op_sel:[0,0,0] op_sel_hi:[1,0,1]
    v_pk_fma_f32 v[12:13], v[66:67], v[18:19], v[12:13] op_sel:[0,0,0] op_sel_hi:[1,0,1]
    v_pk_fma_f32 v[10:11], v[68:69], v[18:19], v[10:11] op_sel:[0,1,0] op_sel_hi:[1,1,1]
    v_pk_fma_f32 v[12:13], v[70:71], v[18:19], v[12:13] op_sel:[0,1,0] op_sel_hi:[1,1,1]
    v_pk_fma_f32 v[10:11], v[72:73], v[20:21], v[10:11] op_sel:[0,0,0] op_sel_hi:[1,0,1]
    v_pk_fma_f32 v[12:13], v[74:75], v[20:21], v[12:13] op_sel:[0,0,0] op_sel_hi:[1,0,1]
    v_pk_fma_f32 v[10:11], v[76:77], v[20:21], v[10:11] op_sel:[0,1,0] op_sel_hi:[1,1,1]
    v_pk_fma_f32 v[12:13], v[78:79], v[20:21], v[12:13] op_sel:[0,1,0] op_sel_hi:[1,1,1]
    v_pk_fma_f32 v[10:11], v[80:81], v[22:23], v[10:11] op_sel:[0,0,0] op_sel_hi:[1,0,1]
    v_pk_fma_f32 v[12:13], v[82:83], v[22:23], v[12:13] op_sel:[0,0,0] op_sel_hi:[1,0,1]
    v_pk_fma_f32 v[10:11], v[84:85], v[22:23], v[10:11] op_sel:[0,1,0] op_sel_hi:[1,1,1]
    v_pk_fma_f32 v[12:13], v[86:87], v[22:23], v[12:13] op_sel:[0,1,0] op_sel_hi:[1,1,1]
    s_mov_b32 exec_lo, 0
    v_add_f32 v10, v10, v11
    v_add_f32 v12, v12, v13
    v_mov_b32 v11, v55
    v_add_f32 v10, v10, v12
    s_mul_i32 s14, s8, 640
    s_mov_b32 exec_lo, 0xffffffff
    s_mov_b32 exec_hi, 0x1
    buffer_store_dwordx4 v[10:13], v32, s[56:59], s14 offen sc1
    s_mov_b64 exec, -1
L_role2:
    s_barrier
    s_cmp_ge_u32 s5, 18
    s_cbranch_scc1 L_wo_c
    s_bitcmp1_b32 s6, 1
    s_cbranch_scc1 L_w2_c
    s_mov_b32 s64, s28
    s_mov_b32 s65, s29
    s_mov_b32 s66, 0x510000
    s_mov_b32 s67, 0x20000
    s_mov_b32 s68, s30
    s_mov_b32 s69, s31
    s_mov_b32 s70, 0x510000
    s_mov_b32 s71, 0x20000
    v_lshrrev_b32 v32, 3, v0
    v_and_b32 v33, 48, v0
    v_add_u32 v32, v32, v33
    s_mul_i32 s14, s3, 663552
    s_lshl_b32 s15, s9, 6
    s_add_u32 s14, s14, s15
    v_and_b32 v33, 3, v0
    v_lshlrev_b32 v33, 4, v33
    v_add_u32 v33, s14, v33
    s_movk_i32 s15, 9216
    v_mad_u32_u24 v35, v32, s15, v33
    s_mov_b32 exec_lo, 0xf0f0f0f0
    s_mov_b32 exec_hi, 0xf0f0f0f0
    s_mov_b32 s14, 36864
    buffer_load_dwordx4 v[192:195], v35, s[68:71], s14 offen nt
    s_mov_b32 s14, 55296
    buffer_load_dwordx4 v[196:199], v35, s[68:71], s14 offen nt
    s_mov_b32 s14, 73728
    buffer_load_dwordx4 v[200:203], v35, s[68:71], s14 offen nt
    s_mov_b32 s14, 92160
    buffer_load_dwordx4 v[204:207], v35, s[68:71], s14 offen nt
    s_mov_b32 s14, 110592
    buffer_load_dwordx4 v[208:211], v35, s[68:71], s14 offen nt
    s_mov_b32 s14, 129024
    buffer_load_dwordx4 v[212:215], v35, s[68:71], s14 offen nt
    s_mov_b32 s14, 147456
    buffer_load_dwordx4 v[216:219], v35, s[68:71], s14 offen nt
    s_mov_b64 exec, -1
    s_cmp_ge_u32 s3, 5
    s_cbranch_scc1 L_wn_c0
    s_mov_b32 s72, s32
    s_mov_b32 s73, s33
    s_mov_b32 s74, 0x510000
    s_mov_b32 s75, 0x20000
    v_lshrrev_b32 v32, 4, v0
    v_and_b32 v34, 15, v0
    v_lshlrev_b32 v34, 4, v34
    s_mul_i32 s14, s9, 36864
    s_lshl_b32 s15, s3, 8
    s_add_u32 s14, s14, s15
    v_add_u32 v34, s14, v34
    s_movk_i32 s15, 9216
    v_mad_u32_u24 v34, v32, s15, v34
    s_movk_i32 s14, 0
    buffer_load_dwordx4 v[220:223], v34, s[72:75], s14 offen nt
    s_movk_i32 s14, 1152
    buffer_load_dwordx4 v[224:227], v34, s[72:75], s14 offen nt
    s_movk_i32 s14, 2304
    buffer_load_dwordx4 v[228:231], v34, s[72:75], s14 offen nt
    s_movk_i32 s14, 3456
    buffer_load_dwordx4 v[232:235], v34, s[72:75], s14 offen nt
    s_movk_i32 s14, 4608
    buffer_load_dwordx4 v[236:239], v34, s[72:75], s14 offen nt
    s_movk_i32 s14, 5760
    buffer_load_dwordx4 v[240:243], v34, s[72:75], s14 offen nt
    s_movk_i32 s14, 6912
    buffer_load_dwordx4 v[244:247], v34, s[72:75], s14 offen nt
    s_movk_i32 s14, 8064
    buffer_load_dwordx4 v[248:251], v34, s[72:75], s14 offen nt
    s_branch L_wp
L_wn_c0:
    s_branch L_wp
L_w2_c:
    s_mov_b32 s64, s28
    s_mov_b32 s65, s29
    s_mov_b32 s66, 0x510000
    s_mov_b32 s67, 0x20000
    s_mov_b32 s68, s30
    s_mov_b32 s69, s31
    s_mov_b32 s70, 0x510000
    s_mov_b32 s71, 0x20000
    v_lshrrev_b32 v32, 3, v0
    v_and_b32 v33, 48, v0
    v_add_u32 v32, v32, v33
    s_mul_i32 s14, s3, 663552
    s_lshl_b32 s15, s9, 6
    s_add_u32 s14, s14, s15
    v_and_b32 v33, 3, v0
    v_lshlrev_b32 v33, 4, v33
    v_add_u32 v33, s14, v33
    s_movk_i32 s15, 9216
    v_mad_u32_u24 v35, v32, s15, v33
    s_mov_b32 exec_lo, 0xf0f0f0f0
    s_mov_b32 exec_hi, 0xf0f0f0f0
    s_mov_b32 s14, 92160
    buffer_load_dwordx4 v[204:207], v35, s[68:71], s14 offen nt
    s_mov_b32 s14, 110592
    buffer_load_dwordx4 v[208:211], v35, s[68:71], s14 offen nt
    s_mov_b32 s14, 129024
    buffer_load_dwordx4 v[212:215], v35, s[68:71], s14 offen nt
    s_mov_b32 s14, 147456
    buffer_load_dwordx4 v[216:219], v35, s[68:71], s14 offen nt
    s_mov_b64 exec, -1
    s_cmp_ge_u32 s3, 5
    s_cbranch_scc1 L_wn_c1
    s_mov_b32 s72, s32
    s_mov_b32 s73, s33
    s_mov_b32 s74, 0x510000
    s_mov_b32 s75, 0x20000
    v_lshrrev_b32 v32, 4, v0
    v_and_b32 v34, 15, v0
    v_lshlrev_b32 v34, 4, v34
    s_mul_i32 s14, s9, 36864
    s_lshl_b32 s15, s3, 8
    s_add_u32 s14, s14, s15
    v_add_u32 v34, s14, v34
    s_movk_i32 s15, 9216
    v_mad_u32_u24 v34, v32, s15, v34
    s_movk_i32 s14, 0
    buffer_load_dwordx4 v[220:223], v34, s[72:75], s14 offen nt
    s_movk_i32 s14, 1152
    buffer_load_dwordx4 v[224:227], v34, s[72:75], s14 offen nt
    s_movk_i32 s14, 2304
    buffer_load_dwordx4 v[228:231], v34, s[72:75], s14 offen nt
    s_movk_i32 s14, 3456
    buffer_load_dwordx4 v[232:235], v34, s[72:75], s14 offen nt
    s_movk_i32 s14, 4608
    buffer_load_dwordx4 v[236:239], v34, s[72:75], s14 offen nt
    s_movk_i32 s14, 5760
    buffer_load_dwordx4 v[240:243], v34, s[72:75], s14 offen nt
    s_movk_i32 s14, 6912
    buffer_load_dwordx4 v[244:247], v34, s[72:75], s14 offen nt
    s_movk_i32 s14, 8064
    buffer_load_dwordx4 v[248:251], v34, s[72:75], s14 offen nt
    s_branch L_wp
L_wn_c1:
    s_branch L_wp
L_wo_c:
    s_branch L_wp
L_wp:
    s_mov_b32 s91, 0
    s_cmp_ge_u32 s2, 252
    s_cbranch_scc1 L_fin0
    s_cmp_ge_u32 s5, 27
    s_cbranch_scc1 L_fin
    v_and_b32 v32, 7, v0
    v_lshrrev_b32 v33, 3, v0
    v_lshlrev_b32 v52, 3, v32
    v_bfe_u32 v53, v0, 4, 1
    v_lshl_add_u32 v52, v53, 2, v52
    v_mul_u32_u24 v52, 80, v52
    v_lshrrev_b32 v53, 5, v0
    v_lshl_add_u32 v52, v53, 2, v52
    s_lshl_b32 s14, s3, 3
    v_add_u32 v52, s14, v52
    s_cmp_lt_u32 s5, 18
    s_cbranch_scc1 L_mlp
    s_lshl_b32 s14, s4, 2
    s_lshr_b32 s15, s3, 1
    s_add_u32 s14, s14, s15
    s_mul_i32 s14, s14, 5120
    v_mul_u32_u24 v34, 640, v32
    v_add_u32 v34, s14, v34
    s_and_b32 s15, s3, 1
    s_lshl_b32 s15, s15, 8
    v_lshlrev_b32 v35, 5, v33
    v_add3_u32 v35, v35, v34, s15
    v_mul_u32_u24 v51, 80, v0
    v_lshlrev_b32 v50, 2, v0
    v_and_b32 v36, 3, v0
    v_mul_u32_u24 v36, 18428, v36
    v_add_u32 v50, v50, v36
L_wo2:
    s_mov_b32 s14, 0x20000
L_poll0:
    buffer_load_dwordx2 v[128:129], v34, s[56:59], 0 offen offset:512 sc1
    buffer_load_dwordx4 v[120:123], v35, s[56:59], 0 offen sc1
    buffer_load_dwordx4 v[124:127], v35, s[56:59], 0 offen offset:16 sc1
    s_waitcnt vmcnt(0)
    v_max_u32 v38, v120, v121
    v_max3_u32 v38, v38, v122, v123
    v_max3_u32 v38, v38, v124, v125
    v_max3_u32 v38, v38, v126, v127
    v_max3_u32 v38, v38, v128, v129
    v_cmp_eq_u32 vcc, -1, v38
    s_cbranch_vccz L_pok0
    s_mov_b64 exec, vcc
    s_sub_u32 s14, s14, 1
    s_cbranch_scc0 L_poll0
L_pok0:
    s_mov_b64 exec, -1
    v_max_f32_dpp v38, v129, v129 quad_perm:[1,0,3,2] row_mask:0xf bank_mask:0xf
    s_nop 1
    v_max_f32_dpp v38, v38, v38 quad_perm:[2,3,0,1] row_mask:0xf bank_mask:0xf
    s_nop 1
    v_max_f32_dpp v38, v38, v38 row_half_mirror row_mask:0xf bank_mask:0xf
    v_sub_f32 v37, v129, v38
    v_mul_f32 v37, 0x3fb8aa3b, v37
    v_exp_f32 v37, v37
    s_nop 0
    v_mul_f32 v36, v128, v37
    v_pk_mul_f32 v[16:17], v[120:121], v[36:37] op_sel:[0,1] op_sel_hi:[1,1]
    v_pk_mul_f32 v[18:19], v[122:123], v[36:37] op_sel:[0,1] op_sel_hi:[1,1]
    v_pk_mul_f32 v[20:21], v[124:125], v[36:37] op_sel:[0,1] op_sel_hi:[1,1]
    v_pk_mul_f32 v[22:23], v[126:127], v[36:37] op_sel:[0,1] op_sel_hi:[1,1]
    v_add_f32_dpp v36, v36, v36 quad_perm:[1,0,3,2] row_mask:0xf bank_mask:0xf
    v_add_f32_dpp v16, v16, v16 quad_perm:[1,0,3,2] row_mask:0xf bank_mask:0xf
    v_add_f32_dpp v17, v17, v17 quad_perm:[1,0,3,2] row_mask:0xf bank_mask:0xf
    v_add_f32_dpp v18, v18, v18 quad_perm:[1,0,3,2] row_mask:0xf bank_mask:0xf
    v_add_f32_dpp v19, v19, v19 quad_perm:[1,0,3,2] row_mask:0xf bank_mask:0xf
    v_add_f32_dpp v20, v20, v20 quad_perm:[1,0,3,2] row_mask:0xf bank_mask:0xf
    v_add_f32_dpp v21, v21, v21 quad_perm:[1,0,3,2] row_mask:0xf bank_mask:0xf
    v_add_f32_dpp v22, v22, v22 quad_perm:[1,0,3,2] row_mask:0xf bank_mask:0xf
    v_add_f32_dpp v23, v23, v23 quad_perm:[1,0,3,2] row_mask:0xf bank_mask:0xf
    v_add_f32_dpp v36, v36, v36 quad_perm:[2,3,0,1] row_mask:0xf bank_mask:0xf
    v_add_f32_dpp v16, v16, v16 quad_perm:[2,3,0,1] row_mask:0xf bank_mask:0xf
    v_add_f32_dpp v17, v17, v17 quad_perm:[2,3,0,1] row_mask:0xf bank_mask:0xf
    v_add_f32_dpp v18, v18, v18 quad_perm:[2,3,0,1] row_mask:0xf bank_mask:0xf
    v_add_f32_dpp v19, v19, v19 quad_perm:[2,3,0,1] row_mask:0xf bank_mask:0xf
    v_add_f32_dpp v20, v20, v20 quad_perm:[2,3,0,1] row_mask:0xf bank_mask:0xf
    v_add_f32_dpp v21, v21, v21 quad_perm:[2,3,0,1] row_mask:0xf bank_mask:0xf
    v_add_f32_dpp v22, v22, v22 quad_perm:[2,3,0,1] row_mask:0xf bank_mask:0xf
    v_add_f32_dpp v23, v23, v23 quad_perm:[2,3,0,1] row_mask:0xf bank_mask:0xf
    v_add_f32_dpp v36, v36, v36 row_half_mirror row_mask:0xf bank_mask:0xf
    v_add_f32_dpp v16, v16, v16 row_half_mirror row_mask:0xf bank_mask:0xf
    v_add_f32_dpp v17, v17, v17 row_half_mirror row_mask:0xf bank_mask:0xf
    v_add_f32_dpp v18, v18, v18 row_half_mirror row_mask:0xf bank_mask:0xf
    v_add_f32_dpp v19, v19, v19 row_half_mirror row_mask:0xf bank_mask:0xf
    v_add_f32_dpp v20, v20, v20 row_half_mirror row_mask:0xf bank_mask:0xf
    v_add_f32_dpp v21, v21, v21 row_half_mirror row_mask:0xf bank_mask:0xf
    v_add_f32_dpp v22, v22, v22 row_half_mirror row_mask:0xf bank_mask:0xf
    v_add_f32_dpp v23, v23, v23 row_half_mirror row_mask:0xf bank_mask:0xf
    v_rcp_f32 v36, v36
    s_nop 0
    v_pk_mul_f32 v[16:17], v[16:17], v[36:37] op_sel_hi:[1,0]
    v_pk_mul_f32 v[18:19], v[18:19], v[36:37] op_sel_hi:[1,0]
    v_pk_mul_f32 v[20:21], v[20:21], v[36:37] op_sel_hi:[1,0]
    v_pk_mul_f32 v[22:23], v[22:23], v[36:37] op_sel_hi:[1,0]
    v_cvt_pk_bf16_f32 v16, v16, v16
    v_cvt_pk_bf16_f32 v17, v17, v17
    v_cvt_pk_bf16_f32 v18, v18, v18
    v_cvt_pk_bf16_f32 v19, v19, v19
    v_cvt_pk_bf16_f32 v20, v20, v20
    v_cvt_pk_bf16_f32 v21, v21, v21
    v_cvt_pk_bf16_f32 v22, v22, v22
    v_cvt_pk_bf16_f32 v23, v23, v23
    v_and_b32 v24, v16, v2
    v_and_b32 v25, v16, v3
    v_and_b32 v26, v16, v4
    v_and_b32 v27, v16, v5
    v_and_b32 v28, v17, v2
    v_and_b32 v29, v17, v3
    v_and_b32 v30, v17, v4
    v_and_b32 v31, v17, v5
    v_mfma_f32_16x16x32_bf16 v[10:13], v[24:27], v[184:187], 0
    v_and_b32 v24, v18, v2
    v_and_b32 v25, v18, v3
    v_and_b32 v26, v18, v4
    v_and_b32 v27, v18, v5
    v_mfma_f32_16x16x32_bf16 v[10:13], v[28:31], v[188:191], v[10:13]
    v_and_b32 v28, v19, v2
    v_and_b32 v29, v19, v3
    v_and_b32 v30, v19, v4
    v_and_b32 v31, v19, v5
    v_mfma_f32_16x16x32_bf16 v[10:13], v[24:27], v[192:195], v[10:13]
    v_and_b32 v24, v20, v2
    v_and_b32 v25, v20, v3
    v_and_b32 v26, v20, v4
    v_and_b32 v27, v20, v5
    v_mfma_f32_16x16x32_bf16 v[10:13], v[28:31], v[196:199], v[10:13]
    v_and_b32 v28, v21, v2
    v_and_b32 v29, v21, v3
    v_and_b32 v30, v21, v4
    v_and_b32 v31, v21, v5
    v_mfma_f32_16x16x32_bf16 v[10:13], v[24:27], v[200:203], v[10:13]
    v_and_b32 v24, v22, v2
    v_and_b32 v25, v22, v3
    v_and_b32 v26, v22, v4
    v_and_b32 v27, v22, v5
    v_mfma_f32_16x16x32_bf16 v[10:13], v[28:31], v[204:207], v[10:13]
    v_and_b32 v28, v23, v2
    v_and_b32 v29, v23, v3
    v_and_b32 v30, v23, v4
    v_and_b32 v31, v23, v5
    v_mfma_f32_16x16x32_bf16 v[10:13], v[24:27], v[208:211], v[10:13]
    s_nop 0
    v_mfma_f32_16x16x32_bf16 v[10:13], v[28:31], v[212:215], v[10:13]
    s_mov_b32 exec_lo, 0xff00ff
    s_mov_b32 exec_hi, 0xff00ff00
    s_nop 5
    ds_write_b32 v52, v10 offset:11264
    ds_write_b32 v52, v11 offset:11344
    ds_write_b32 v52, v12 offset:11424
    ds_write_b32 v52, v13 offset:11504
    s_mov_b64 exec, -1
    s_waitcnt lgkmcnt(0)
    s_barrier
    s_cmp_lg_u32 s3, 0
    s_cbranch_scc1 L_wo3
    ds_read_b128 v[56:59], v51 offset:11264
    ds_read_b128 v[60:63], v51 offset:11280
    ds_read_b128 v[64:67], v51 offset:11296
    ds_read_b128 v[68:71], v51 offset:11312
    s_waitcnt lgkmcnt(0)
    v_pk_add_f32 v[56:57], v[56:57], v[58:59]
    v_pk_add_f32 v[60:61], v[60:61], v[62:63]
    v_pk_add_f32 v[64:65], v[64:65], v[66:67]
    v_pk_add_f32 v[68:69], v[68:69], v[70:71]
    v_pk_add_f32 v[56:57], v[56:57], v[60:61]
    v_pk_add_f32 v[64:65], v[64:65], v[68:69]
    v_pk_add_f32 v[56:57], v[56:57], v[64:65]
    v_add_f32 v10, v56, v57
    s_nop 1
    v_mov_b32_dpp v11, v10 quad_perm:[1,1,1,1] row_mask:0xf bank_mask:0xf
    v_mov_b32_dpp v12, v10 quad_perm:[2,2,2,2] row_mask:0xf bank_mask:0xf
    v_mov_b32_dpp v13, v10 quad_perm:[3,3,3,3] row_mask:0xf bank_mask:0xf
    v_mov_b32_dpp v10, v10 quad_perm:[0,0,0,0] row_mask:0xf bank_mask:0xf
    s_mul_i32 s14, s4, 2304
    s_lshl_b32 s15, s9, 8
    s_add_u32 s14, s14, s15
    s_add_u32 s14, s14, 163840
    buffer_store_dwordx4 v[10:13], v50, s[56:59], s14 offen sc1
    s_waitcnt vmcnt(0)
    s_endpgm
L_wo3:
    s_endpgm
L_mlp:
    s_and_b32 s96, s2, 3
    s_mul_i32 s96, s96, 0x4800
    s_add_u32 s96, s96, 163840
    s_mul_i32 s14, s3, 288
    v_and_b32 v34, 15, v0
    v_lshrrev_b32 v35, 4, v0
    v_mul_u32_u24 v37, 72, v35
    v_lshl_add_u32 v37, v34, 3, v37
    v_add_u32 v37, s14, v37
    v_cmp_gt_u32 vcc, 9, v34
    v_mov_b32 v34, 0x200000
    s_nop 0
    v_cndmask_b32 v37, v34, v37, vcc
    v_lshrrev_b32 v35, 1, v37
    buffer_load_dword v92, v35, s[48:51], 0 offen
    v_add_u32 v36, s96, v37
    v_and_b32 v34, 8, v0
    v_cmp_eq_u32 vcc, 0, v34
    v_mov_b32 v34, 0x03020302
    v_mov_b32 v35, 0x01000100
    v_cndmask_b32 v34, v34, v35, vcc
    v_mov_b32 v35, 0x0c0c0c0c
    v_bfi_b32 v152, v2, v34, v35
    v_and_b32 v156, 0x3f803f80, v2
    v_bfi_b32 v153, v3, v34, v35
    v_and_b32 v157, 0x3f803f80, v3
    v_bfi_b32 v154, v4, v34, v35
    v_and_b32 v158, 0x3f803f80, v4
    v_bfi_b32 v155, v5, v34, v35
    v_and_b32 v159, 0x3f803f80, v5
    v_and_b32 v170, 7, v0
    v_bfe_u32 v34, v0, 4, 1
    v_lshlrev_b32 v34, 2, v34
    v_lshl_add_u32 v170, v170, 3, v34
    v_mul_u32_u24 v170, 80, v170
    s_lshl_b32 s15, s3, 2
    v_add_u32 v170, s15, v170
    s_lshl_b32 s15, s3, 3
    v_mov_b32 v171, s15
    v_lshl_add_u32 v39, v33, 2, s14
    v_lshl_add_u32 v38, v32, 5, v39
    v_lshlrev_b32 v51, 2, v0
    v_lshrrev_b32 v53, 4, v0
    v_lshl_add_u32 v53, v53, 3, v32
    v_and_b32 v32, 8, v0
    v_lshl_add_u32 v53, v32, 2, v53
    v_mul_u32_u24 v53, 80, v53
    v_and_b32 v32, 15, v0
    v_lshlrev_b32 v32, 5, v32
    v_and_b32 v33, 16, v0
    s_lshl_b32 s14, s3, 9
    v_add3_u32 v90, v32, v33, s14
    v_mul_u32_u24 v91, 2304, v0
    s_lshl_b32 s14, s5, 7
    s_add_u32 s14, s14, s96
    v_add_u32 v91, s14, v91
    s_mul_i32 s92, s9, 2304
    s_add_u32 s92, s92, 262144
    s_movk_i32 s93, 4608
    s_movk_i32 s94, 9216
    s_movk_i32 s95, 13824
L_mlp2:
    s_cmp_lg_u32 s3, 7
    s_cbranch_scc1 L_ph1
    s_mov_b64 exec, 0xff
    s_mov_b32 s14, 0x20000
L_poll1:
    buffer_load_dword v32, v91, s[56:59], 0 offen sc1
    s_waitcnt vmcnt(0)
    v_cmp_ne_u32 vcc, -1, v32
    s_cbranch_vccnz L_pok1
    s_sub_u32 s14, s14, 1
    s_cbranch_scc0 L_poll1
L_pok1:
    s_mov_b64 exec, -1
L_ph1:
    s_barrier
    s_mov_b32 s14, 0x20000
    s_mov_b64 s[16:17], -1
    s_mov_b64 s[18:19], -1
    s_mov_b64 s[20:21], -1
    s_mov_b64 s[22:23], -1
    s_mov_b64 s[24:25], -1
    s_mov_b64 s[26:27], -1
    s_mov_b64 s[28:29], -1
    s_mov_b64 s[30:31], -1
    buffer_load_dwordx2 v[120:121], v36, s[56:59], 0 offen offset:0 sc1
    buffer_load_dwordx2 v[122:123], v36, s[56:59], 0 offen offset:2304 sc1
    buffer_load_dwordx2 v[124:125], v36, s[56:59], s93 offen offset:0 sc1
    buffer_load_dwordx2 v[126:127], v36, s[56:59], s93 offen offset:2304 sc1
    buffer_load_dwordx2 v[128:129], v36, s[56:59], s94 offen offset:0 sc1
    buffer_load_dwordx2 v[130:131], v36, s[56:59], s94 offen offset:2304 sc1
    buffer_load_dwordx2 v[132:133], v36, s[56:59], s95 offen offset:0 sc1
    buffer_load_dwordx2 v[134:135], v36, s[56:59], s95 offen offset:2304 sc1
    s_waitcnt vmcnt(8)
    v_mfma_f32_16x16x32_bf16 v[160:163], v[156:159], v[184:187], 0
    v_mfma_f32_16x16x32_bf16 v[160:163], v[156:159], v[188:191], v[160:163]
    v_mfma_f32_16x16x32_bf16 v[160:163], v[156:159], v[192:195], v[160:163]
    v_mfma_f32_16x16x32_bf16 v[160:163], v[156:159], v[196:199], v[160:163]
    v_mfma_f32_16x16x32_bf16 v[160:163], v[156:159], v[200:203], v[160:163]
    v_mfma_f32_16x16x32_bf16 v[160:163], v[156:159], v[204:207], v[160:163]
    v_mfma_f32_16x16x32_bf16 v[160:163], v[156:159], v[208:211], v[160:163]
    v_mfma_f32_16x16x32_bf16 v[160:163], v[156:159], v[212:215], v[160:163]
    v_mfma_f32_16x16x32_bf16 v[160:163], v[156:159], v[216:219], v[160:163]
    v_and_b32 v89, 0xffff0000, v92
    v_lshlrev_b32 v88, 16, v92
    s_nop 5
    v_add_f32_dpp v160, v160, v160 row_ror:8 row_mask:0xf bank_mask:0xf
    v_add_f32_dpp v161, v161, v161 row_ror:8 row_mask:0xf bank_mask:0xf
    v_add_f32_dpp v162, v162, v162 row_ror:8 row_mask:0xf bank_mask:0xf
    v_add_f32_dpp v163, v163, v163 row_ror:8 row_mask:0xf bank_mask:0xf
    s_mov_b32 exec_lo, 0xff00ff
    s_mov_b32 exec_hi, 0x0
    ds_write_b32 v170, v160 offset:4096
    ds_write_b32 v170, v161 offset:4176
    ds_write_b32 v170, v162 offset:4256
    ds_write_b32 v170, v163 offset:4336
    s_branch L_chk2
L_poll2:
    s_mov_b64 exec, s[16:17]
    s_cbranch_execz L_sk2_0
    buffer_load_dwordx2 v[120:121], v36, s[56:59], 0 offen offset:0 sc1
L_sk2_0:
    s_mov_b64 exec, s[18:19]
    s_cbranch_execz L_sk2_1
    buffer_load_dwordx2 v[122:123], v36, s[56:59], 0 offen offset:2304 sc1
L_sk2_1:
    s_mov_b64 exec, s[20:21]
    s_cbranch_execz L_sk2_2
    buffer_load_dwordx2 v[124:125], v36, s[56:59], s93 offen offset:0 sc1
L_sk2_2:
    s_mov_b64 exec, s[22:23]
    s_cbranch_execz L_sk2_3
    buffer_load_dwordx2 v[126:127], v36, s[56:59], s93 offen offset:2304 sc1
L_sk2_3:
    s_mov_b64 exec, s[24:25]
    s_cbranch_execz L_sk2_4
    buffer_load_dwordx2 v[128:129], v36, s[56:59], s94 offen offset:0 sc1
L_sk2_4:
    s_mov_b64 exec, s[26:27]
    s_cbranch_execz L_sk2_5
    buffer_load_dwordx2 v[130:131], v36, s[56:59], s94 offen offset:2304 sc1
L_sk2_5:
    s_mov_b64 exec, s[28:29]
    s_cbranch_execz L_sk2_6
    buffer_load_dwordx2 v[132:133], v36, s[56:59], s95 offen offset:0 sc1
L_sk2_6:
    s_mov_b64 exec, s[30:31]
    s_cbranch_execz L_sk2_7
    buffer_load_dwordx2 v[134:135], v36, s[56:59], s95 offen offset:2304 sc1
L_sk2_7:
L_chk2:
    s_mov_b64 exec, -1
    s_waitcnt vmcnt(0)
    v_max_u32 v24, v120, v121
    v_max_u32 v25, v122, v123
    v_max_u32 v26, v124, v125
    v_max_u32 v27, v126, v127
    v_max_u32 v28, v128, v129
    v_max_u32 v29, v130, v131
    v_max_u32 v30, v132, v133
    v_max_u32 v31, v134, v135
    v_cmp_eq_u32 s[16:17], -1, v24
    v_cmp_eq_u32 s[18:19], -1, v25
    v_cmp_eq_u32 s[20:21], -1, v26
    v_cmp_eq_u32 s[22:23], -1, v27
    v_cmp_eq_u32 s[24:25], -1, v28
    v_cmp_eq_u32 s[26:27], -1, v29
    v_cmp_eq_u32 s[28:29], -1, v30
    v_cmp_eq_u32 s[30:31], -1, v31
    s_or_b64 vcc, s[16:17], s[18:19]
    s_or_b64 vcc, vcc, s[20:21]
    s_or_b64 vcc, vcc, s[22:23]
    s_or_b64 vcc, vcc, s[24:25]
    s_or_b64 vcc, vcc, s[26:27]
    s_or_b64 vcc, vcc, s[28:29]
    s_or_b64 vcc, vcc, s[30:31]
    s_cbranch_scc0 L_pok2
    s_sub_u32 s14, s14, 1
    s_cbranch_scc0 L_poll2
L_pok2:
    s_mov_b64 exec, -1
    v_pk_add_f32 v[120:121], v[120:121], v[122:123]
    v_pk_add_f32 v[124:125], v[124:125], v[126:127]
    v_pk_add_f32 v[128:129], v[128:129], v[130:131]
    v_pk_add_f32 v[132:133], v[132:133], v[134:135]
    v_pk_add_f32 v[120:121], v[120:121], v[124:125]
    v_pk_add_f32 v[128:129], v[128:129], v[132:133]
    v_pk_add_f32 v[16:17], v[120:121], v[128:129]
    v_cvt_pk_bf16_f32 v16, v16, v17
    v_and_b32 v17, 0xffff0000, v16
    v_lshlrev_b32 v16, 16, v16
    v_pk_add_f32 v[16:17], v[16:17], v[88:89]
    v_cvt_pk_bf16_f32 v166, v16, v17
    s_nop 1
    v_mov_b32_dpp v16, v166 row_newbcast:0 row_mask:0xf bank_mask:0xf
    v_and_b32 v168, 0xffff0000, v166
    v_lshlrev_b32 v167, 16, v166
    v_perm_b32 v24, v16, v16, v152
    v_perm_b32 v25, v16, v16, v153
    v_perm_b32 v26, v16, v16, v154
    v_perm_b32 v27, v16, v16, v155
    v_mov_b32_dpp v17, v166 row_newbcast:1 row_mask:0xf bank_mask:0xf
    v_add_f32 v164, v167, v168
    v_mul_f32 v165, v167, v167
    v_perm_b32 v28, v17, v17, v152
    v_perm_b32 v29, v17, v17, v153
    v_perm_b32 v30, v17, v17, v154
    v_perm_b32 v31, v17, v17, v155
    v_mfma_f32_16x16x32_bf16 v[10:13], v[24:27], v[184:187], 0
    v_mov_b32_dpp v16, v166 row_newbcast:2 row_mask:0xf bank_mask:0xf
    v_fmac_f32 v165, v168, v168
    v_perm_b32 v24, v16, v16, v152
    v_perm_b32 v25, v16, v16, v153
    v_perm_b32 v26, v16, v16, v154
    v_perm_b32 v27, v16, v16, v155
    v_mfma_f32_16x16x32_bf16 v[10:13], v[28:31], v[188:191], v[10:13]
    v_mov_b32_dpp v17, v166 row_newbcast:3 row_mask:0xf bank_mask:0xf
    v_add_f32_dpp v164, v164, v164 quad_perm:[1,0,3,2] row_mask:0xf bank_mask:0xf
    v_add_f32_dpp v165, v165, v165 quad_perm:[1,0,3,2] row_mask:0xf bank_mask:0xf
    v_perm_b32 v28, v17, v17, v152
    v_perm_b32 v29, v17, v17, v153
    v_perm_b32 v30, v17, v17, v154
    v_perm_b32 v31, v17, v17, v155
    v_mfma_f32_16x16x32_bf16 v[10:13], v[24:27], v[192:195], v[10:13]
    v_mov_b32_dpp v16, v166 row_newbcast:4 row_mask:0xf bank_mask:0xf
    v_add_f32_dpp v164, v164, v164 quad_perm:[2,3,0,1] row_mask:0xf bank_mask:0xf
    v_add_f32_dpp v165, v165, v165 quad_perm:[2,3,0,1] row_mask:0xf bank_mask:0xf
    v_perm_b32 v24, v16, v16, v152
    v_perm_b32 v25, v16, v16, v153
    v_perm_b32 v26, v16, v16, v154
    v_perm_b32 v27, v16, v16, v155
    v_mfma_f32_16x16x32_bf16 v[10:13], v[28:31], v[196:199], v[10:13]
    v_mov_b32_dpp v17, v166 row_newbcast:5 row_mask:0xf bank_mask:0xf
    v_add_f32_dpp v164, v164, v164 row_half_mirror row_mask:0xf bank_mask:0xf
    v_add_f32_dpp v165, v165, v165 row_half_mirror row_mask:0xf bank_mask:0xf
    v_perm_b32 v28, v17, v17, v152
    v_perm_b32 v29, v17, v17, v153
    v_perm_b32 v30, v17, v17, v154
    v_perm_b32 v31, v17, v17, v155
    v_mfma_f32_16x16x32_bf16 v[10:13], v[24:27], v[200:203], v[10:13]
    v_mov_b32_dpp v16, v166 row_newbcast:6 row_mask:0xf bank_mask:0xf
    v_add_f32_dpp v164, v164, v164 row_ror:8 row_mask:0xf bank_mask:0xf
    v_add_f32_dpp v165, v165, v165 row_ror:8 row_mask:0xf bank_mask:0xf
    v_perm_b32 v24, v16, v16, v152
    v_perm_b32 v25, v16, v16, v153
    v_perm_b32 v26, v16, v16, v154
    v_perm_b32 v27, v16, v16, v155
    v_mfma_f32_16x16x32_bf16 v[10:13], v[28:31], v[204:207], v[10:13]
    v_mov_b32_dpp v17, v166 row_newbcast:7 row_mask:0xf bank_mask:0xf
    v_add_f32_dpp v164, v164, v164 row_bcast:15 row_mask:0xa bank_mask:0xf
    v_add_f32_dpp v165, v165, v165 row_bcast:15 row_mask:0xa bank_mask:0xf
    v_perm_b32 v28, v17, v17, v152
    v_perm_b32 v29, v17, v17, v153
    v_perm_b32 v30, v17, v17, v154
    v_perm_b32 v31, v17, v17, v155
    v_mfma_f32_16x16x32_bf16 v[10:13], v[24:27], v[208:211], v[10:13]
    v_mov_b32_dpp v16, v166 row_newbcast:8 row_mask:0xf bank_mask:0xf
    v_add_f32_dpp v164, v164, v164 row_bcast:31 row_mask:0xc bank_mask:0xf
    v_add_f32_dpp v165, v165, v165 row_bcast:31 row_mask:0xc bank_mask:0xf
    v_perm_b32 v24, v16, v16, v152
    v_perm_b32 v25, v16, v16, v153
    v_perm_b32 v26, v16, v16, v154
    v_perm_b32 v27, v16, v16, v155
    v_mfma_f32_16x16x32_bf16 v[10:13], v[28:31], v[212:215], v[10:13]
    s_nop 0
    v_mfma_f32_16x16x32_bf16 v[10:13], v[24:27], v[216:219], v[10:13]
    s_mov_b32 exec_lo, 0x0
    s_mov_b32 exec_hi, 0x80000000
    ds_write_b64 v171, v[164:165] offset:9216
    s_mov_b32 exec_lo, 0xff00ff
    s_mov_b32 exec_hi, 0xff00ff00
    s_nop 2
    ds_write_b32 v52, v10 offset:11264
    ds_write_b32 v52, v11 offset:11344
    ds_write_b32 v52, v12 offset:11424
    ds_write_b32 v52, v13 offset:11504
    s_mov_b64 exec, -1
    s_waitcnt lgkmcnt(0)
    s_barrier
    s_cmp_ge_u32 s3, 5
    s_cbranch_scc1 L_mlp3
    ds_read_b128 v[120:123], v54 offset:9216
    ds_read_b128 v[124:127], v54 offset:9232
    ds_read_b128 v[128:131], v54 offset:9248
    ds_read_b128 v[132:135], v54 offset:9264
    ds_read_b128 v[136:139], v53 offset:4096
    ds_read_b128 v[140:143], v53 offset:4112
    ds_read_b128 v[56:59], v53 offset:11264
    ds_read_b128 v[60:63], v53 offset:11280
    ds_read_b128 v[64:67], v53 offset:11296
    ds_read_b128 v[68:71], v53 offset:11312
    s_waitcnt lgkmcnt(6)
    v_pk_add_f32 v[120:121], v[120:121], v[122:123]
    v_pk_add_f32 v[124:125], v[124:125], v[126:127]
    v_pk_add_f32 v[128:129], v[128:129], v[130:131]
    v_pk_add_f32 v[132:133], v[132:133], v[134:135]
    v_pk_add_f32 v[120:121], v[120:121], v[124:125]
    v_pk_add_f32 v[128:129], v[128:129], v[132:133]
    v_pk_add_f32 v[164:165], v[120:121], v[128:129]
    s_waitcnt lgkmcnt(4)
    v_pk_add_f32 v[136:137], v[136:137], v[138:139]
    v_pk_add_f32 v[140:141], v[140:141], v[142:143]
    v_mul_f32 v164, 0x3ae38e39, v164
    v_mul_f32 v165, 0x3ae38e39, v165
    v_fma_f32 v165, -v164, v164, v165
    v_pk_add_f32 v[136:137], v[136:137], v[140:141]
    v_max_f32 v165, 0, v165
    v_add_f32 v166, v136, v137
    v_cvt_pk_bf16_f32 v165, v164, v165
    v_lshlrev_b32 v164, 16, v165
    v_and_b32 v165, 0xffff0000, v165
    v_add_f32 v165, 0x3727c5ac, v165
    v_cvt_pk_bf16_f32 v165, v165, v165
    v_and_b32 v165, 0xffff0000, v165
    v_sqrt_f32 v165, v165
    s_waitcnt lgkmcnt(0)
    v_pk_add_f32 v[56:57], v[56:57], v[58:59]
    v_pk_add_f32 v[60:61], v[60:61], v[62:63]
    v_pk_add_f32 v[64:65], v[64:65], v[66:67]
    v_pk_add_f32 v[68:69], v[68:69], v[70:71]
    v_cvt_pk_bf16_f32 v165, v165, v165
    v_and_b32 v165, 0xffff0000, v165
    v_pk_add_f32 v[56:57], v[56:57], v[60:61]
    v_pk_add_f32 v[64:65], v[64:65], v[68:69]
    v_rcp_f32 v165, v165
    v_pk_add_f32 v[56:57], v[56:57], v[64:65]
    v_fma_f32 v56, -v164, v166, v56
    v_add_f32 v16, v56, v57
    v_mul_f32 v16, v16, v165
    v_cvt_pk_bf16_f32 v16, v16, v16
    v_and_b32 v16, 0xffff0000, v16
    s_nop 1
    v_mul_f32_dpp v16, v16, v16 row_ror:8 row_mask:0xf bank_mask:0xf
    v_cvt_pk_bf16_f32 v16, v16, v16
    s_nop 1
    v_and_b32_dpp v24, v16, v2 row_newbcast:0 row_mask:0xf bank_mask:0xf
    v_and_b32_dpp v25, v16, v3 row_newbcast:0 row_mask:0xf bank_mask:0xf
    v_and_b32_dpp v26, v16, v4 row_newbcast:0 row_mask:0xf bank_mask:0xf
    v_and_b32_dpp v27, v16, v5 row_newbcast:0 row_mask:0xf bank_mask:0xf
    v_and_b32_dpp v28, v16, v2 row_newbcast:1 row_mask:0xf bank_mask:0xf
    v_and_b32_dpp v29, v16, v3 row_newbcast:1 row_mask:0xf bank_mask:0xf
    v_and_b32_dpp v30, v16, v4 row_newbcast:1 row_mask:0xf bank_mask:0xf
    v_and_b32_dpp v31, v16, v5 row_newbcast:1 row_mask:0xf bank_mask:0xf
    v_mfma_f32_16x16x32_bf16 v[10:13], v[24:27], v[220:223], 0
    v_and_b32_dpp v24, v16, v2 row_newbcast:2 row_mask:0xf bank_mask:0xf
    v_and_b32_dpp v25, v16, v3 row_newbcast:2 row_mask:0xf bank_mask:0xf
    v_and_b32_dpp v26, v16, v4 row_newbcast:2 row_mask:0xf bank_mask:0xf
    v_and_b32_dpp v27, v16, v5 row_newbcast:2 row_mask:0xf bank_mask:0xf
    v_mfma_f32_16x16x32_bf16 v[10:13], v[28:31], v[224:227], v[10:13]
    v_and_b32_dpp v28, v16, v2 row_newbcast:3 row_mask:0xf bank_mask:0xf
    v_and_b32_dpp v29, v16, v3 row_newbcast:3 row_mask:0xf bank_mask:0xf
    v_and_b32_dpp v30, v16, v4 row_newbcast:3 row_mask:0xf bank_mask:0xf
    v_and_b32_dpp v31, v16, v5 row_newbcast:3 row_mask:0xf bank_mask:0xf
    v_mfma_f32_16x16x32_bf16 v[10:13], v[24:27], v[228:231], v[10:13]
    v_and_b32_dpp v24, v16, v2 row_newbcast:4 row_mask:0xf bank_mask:0xf
    v_and_b32_dpp v25, v16, v3 row_newbcast:4 row_mask:0xf bank_mask:0xf
    v_and_b32_dpp v26, v16, v4 row_newbcast:4 row_mask:0xf bank_mask:0xf
    v_and_b32_dpp v27, v16, v5 row_newbcast:4 row_mask:0xf bank_mask:0xf
    v_mfma_f32_16x16x32_bf16 v[10:13], v[28:31], v[232:235], v[10:13]
    v_and_b32_dpp v28, v16, v2 row_newbcast:5 row_mask:0xf bank_mask:0xf
    v_and_b32_dpp v29, v16, v3 row_newbcast:5 row_mask:0xf bank_mask:0xf
    v_and_b32_dpp v30, v16, v4 row_newbcast:5 row_mask:0xf bank_mask:0xf
    v_and_b32_dpp v31, v16, v5 row_newbcast:5 row_mask:0xf bank_mask:0xf
    v_mfma_f32_16x16x32_bf16 v[10:13], v[24:27], v[236:239], v[10:13]
    v_and_b32_dpp v24, v16, v2 row_newbcast:6 row_mask:0xf bank_mask:0xf
    v_and_b32_dpp v25, v16, v3 row_newbcast:6 row_mask:0xf bank_mask:0xf
    v_and_b32_dpp v26, v16, v4 row_newbcast:6 row_mask:0xf bank_mask:0xf
    v_and_b32_dpp v27, v16, v5 row_newbcast:6 row_mask:0xf bank_mask:0xf
    v_mfma_f32_16x16x32_bf16 v[10:13], v[28:31], v[240:243], v[10:13]
    v_and_b32_dpp v28, v16, v2 row_newbcast:7 row_mask:0xf bank_mask:0xf
    v_and_b32_dpp v29, v16, v3 row_newbcast:7 row_mask:0xf bank_mask:0xf
    v_and_b32_dpp v30, v16, v4 row_newbcast:7 row_mask:0xf bank_mask:0xf
    v_and_b32_dpp v31, v16, v5 row_newbcast:7 row_mask:0xf bank_mask:0xf
    v_mfma_f32_16x16x32_bf16 v[10:13], v[24:27], v[244:247], v[10:13]
    s_nop 0
    v_mfma_f32_16x16x32_bf16 v[10:13], v[28:31], v[248:251], v[10:13]
    s_cmp_eq_u32 s3, 4
    s_cselect_b32 exec_lo, 0x00ff00ff, -1
    s_mov_b32 exec_hi, 0
    s_nop 4
    buffer_store_dwordx4 v[10:13], v90, s[56:59], s92 offen sc1
L_fin0:
    s_waitcnt vmcnt(0)
    s_endpgm
L_mlp3:
    s_endpgm
L_fin:
    s_cmp_lg_u32 s3, 0
    s_cbranch_scc1 L_end
    s_mov_b32 s76, s34
    s_mov_b32 s77, s35
    s_mov_b32 s78, 0x480
    s_mov_b32 s79, 0x20000
    s_cmp_lg_u32 s9, 0
    s_cbranch_scc1 L_noep
    s_mov_b64 exec, 1
    s_mov_b32 s14, 983040
    v_mov_b32 v32, s89
    buffer_store_dword v32, v54, s[56:59], s14 offen sc1
    s_mov_b64 exec, -1
L_noep:
    v_and_b32 v32, 3, v0
    v_lshrrev_b32 v33, 2, v0
    s_lshl_b32 s14, s9, 2
    v_add_u32 v32, s14, v32
    v_lshlrev_b32 v34, 3, v32
    v_mul_u32_u24 v33, 2304, v33
    v_lshl_add_u32 v33, v32, 4, v33
    s_and_b32 s96, s2, 3
    s_mul_i32 s96, s96, 0x4800
    s_add_u32 s96, s96, 163840
    v_add_u32 v35, s96, v33
    v_add_u32 v33, 262144, v33
    v_cmp_gt_u32 vcc, 32, v0
    v_mov_b32 v36, 0x200000
    s_nop 0
    v_cndmask_b32 v35, v36, v35, vcc
    buffer_load_dwordx2 v[38:39], v34, s[48:51], 0 offen
L_fin2:
    s_mov_b32 s14, 0x20000
L_poll3:
    buffer_load_dwordx4 v[16:19], v35, s[56:59], 0 offen sc1
    s_waitcnt vmcnt(0)
    v_max_u32 v37, v16, v17
    v_max3_u32 v37, v37, v18, v19
    v_cmp_eq_u32 vcc, -1, v37
    s_cbranch_vccz L_pok3
    s_mov_b64 exec, vcc
    s_sub_u32 s14, s14, 1
    s_cbranch_scc0 L_poll3
L_pok3:
    s_mov_b64 exec, -1
    v_add_f32_dpp v16, v16, v16 row_ror:4 row_mask:0xf bank_mask:0xf
    v_add_f32_dpp v17, v17, v17 row_ror:4 row_mask:0xf bank_mask:0xf
    v_add_f32_dpp v18, v18, v18 row_ror:4 row_mask:0xf bank_mask:0xf
    v_add_f32_dpp v19, v19, v19 row_ror:4 row_mask:0xf bank_mask:0xf
    v_add_f32_dpp v16, v16, v16 row_ror:8 row_mask:0xf bank_mask:0xf
    v_add_f32_dpp v17, v17, v17 row_ror:8 row_mask:0xf bank_mask:0xf
    v_add_f32_dpp v18, v18, v18 row_ror:8 row_mask:0xf bank_mask:0xf
    v_add_f32_dpp v19, v19, v19 row_ror:8 row_mask:0xf bank_mask:0xf
    v_mov_b32 v20, v16
    v_mov_b32 v21, v17
    v_mov_b32 v22, v18
    v_mov_b32 v23, v19
    v_permlane16_swap_b32 v20, v16
    v_permlane16_swap_b32 v21, v17
    v_permlane16_swap_b32 v22, v18
    v_permlane16_swap_b32 v23, v19
    v_add_f32 v16, v20, v16
    v_add_f32 v17, v21, v17
    v_add_f32 v18, v22, v18
    v_add_f32 v19, v23, v19
    v_mov_b32 v20, v16
    v_mov_b32 v21, v17
    v_mov_b32 v22, v18
    v_mov_b32 v23, v19
    v_permlane32_swap_b32 v20, v16
    v_permlane32_swap_b32 v21, v17
    v_permlane32_swap_b32 v22, v18
    v_permlane32_swap_b32 v23, v19
    v_add_f32 v16, v20, v16
    v_add_f32 v17, v21, v17
    v_add_f32 v18, v22, v18
    v_add_f32 v19, v23, v19
    v_cvt_pk_bf16_f32 v16, v16, v16
    v_and_b32 v16, 0xffff0000, v16
    v_cvt_pk_bf16_f32 v17, v17, v17
    v_and_b32 v17, 0xffff0000, v17
    v_cvt_pk_bf16_f32 v18, v18, v18
    v_and_b32 v18, 0xffff0000, v18
    v_cvt_pk_bf16_f32 v19, v19, v19
    v_and_b32 v19, 0xffff0000, v19
    v_lshlrev_b32 v24, 16, v38
    v_and_b32 v25, 0xffff0000, v38
    v_lshlrev_b32 v26, 16, v39
    v_and_b32 v27, 0xffff0000, v39
    v_add_f32 v16, v16, v24
    v_add_f32 v17, v17, v25
    v_add_f32 v18, v18, v26
    v_add_f32 v19, v19, v27
    v_cvt_pk_bf16_f32 v16, v16, v16
    v_and_b32 v16, 0xffff0000, v16
    v_cvt_pk_bf16_f32 v17, v17, v17
    v_and_b32 v17, 0xffff0000, v17
    v_cvt_pk_bf16_f32 v18, v18, v18
    v_and_b32 v18, 0xffff0000, v18
    v_cvt_pk_bf16_f32 v19, v19, v19
    v_and_b32 v19, 0xffff0000, v19
    v_mov_b32_dpp v16, v18 quad_perm:[0,1,2,3] row_mask:0x2 bank_mask:0xf
    s_nop 1
    v_mov_b32_dpp v16, v17 quad_perm:[0,1,2,3] row_mask:0x4 bank_mask:0xf
    s_nop 1
    v_mov_b32_dpp v16, v19 quad_perm:[0,1,2,3] row_mask:0x8 bank_mask:0xf
    v_bfe_u32 v40, v0, 4, 1
    v_lshl_add_u32 v40, v40, 2, v34
    v_lshrrev_b32 v41, 5, v0
    v_lshl_add_u32 v40, v41, 1, v40
    s_mov_b32 s14, 0x20000
L_poll4:
    s_mov_b32 s15, 0
    buffer_load_dwordx4 v[56:59], v33, s[56:59], s15 offen sc1
    s_mov_b32 s15, 36864
    buffer_load_dwordx4 v[60:63], v33, s[56:59], s15 offen sc1
    s_mov_b32 s15, 73728
    buffer_load_dwordx4 v[64:67], v33, s[56:59], s15 offen sc1
    s_mov_b32 s15, 110592
    buffer_load_dwordx4 v[68:71], v33, s[56:59], s15 offen sc1
    s_mov_b32 s15, 147456
    buffer_load_dwordx4 v[72:75], v33, s[56:59], s15 offen sc1
    s_mov_b32 s15, 184320
    buffer_load_dwordx4 v[76:79], v33, s[56:59], s15 offen sc1
    s_mov_b32 s15, 221184
    buffer_load_dwordx4 v[80:83], v33, s[56:59], s15 offen sc1
    s_mov_b32 s15, 258048
    buffer_load_dwordx4 v[84:87], v33, s[56:59], s15 offen sc1
    s_mov_b32 s15, 294912
    buffer_load_dwordx4 v[88:91], v33, s[56:59], s15 offen sc1
    s_waitcnt vmcnt(0)
    v_max_u32 v37, v56, v57
    v_max3_u32 v37, v37, v58, v59
    v_max3_u32 v37, v37, v60, v61
    v_max3_u32 v37, v37, v62, v63
    v_max3_u32 v37, v37, v64, v65
    v_max3_u32 v37, v37, v66, v67
    v_max3_u32 v37, v37, v68, v69
    v_max3_u32 v37, v37, v70, v71
    v_max3_u32 v37, v37, v72, v73
    v_max3_u32 v37, v37, v74, v75
    v_max3_u32 v37, v37, v76, v77
    v_max3_u32 v37, v37, v78, v79
    v_max3_u32 v37, v37, v80, v81
    v_max3_u32 v37, v37, v82, v83
    v_max3_u32 v37, v37, v84, v85
    v_max3_u32 v37, v37, v86, v87
    v_max3_u32 v37, v37, v88, v89
    v_max3_u32 v37, v37, v90, v91
    v_cmp_eq_u32 vcc, -1, v37
    s_cbranch_vccz L_pok4
    s_mov_b64 exec, vcc
    s_sub_u32 s14, s14, 1
    s_cbranch_scc0 L_poll4
L_pok4:
    s_mov_b64 exec, -1
    v_pk_add_f32 v[56:57], v[56:57], v[60:61]
    v_pk_add_f32 v[58:59], v[58:59], v[62:63]
    v_pk_add_f32 v[64:65], v[64:65], v[68:69]
    v_pk_add_f32 v[66:67], v[66:67], v[70:71]
    v_pk_add_f32 v[72:73], v[72:73], v[76:77]
    v_pk_add_f32 v[74:75], v[74:75], v[78:79]
    v_pk_add_f32 v[80:81], v[80:81], v[84:85]
    v_pk_add_f32 v[82:83], v[82:83], v[86:87]
    v_pk_add_f32 v[56:57], v[56:57], v[64:65]
    v_pk_add_f32 v[58:59], v[58:59], v[66:67]
    v_pk_add_f32 v[72:73], v[72:73], v[80:81]
    v_pk_add_f32 v[74:75], v[74:75], v[82:83]
    v_pk_add_f32 v[56:57], v[56:57], v[72:73]
    v_pk_add_f32 v[58:59], v[58:59], v[74:75]
    v_pk_add_f32 v[10:11], v[56:57], v[88:89]
    v_pk_add_f32 v[12:13], v[58:59], v[90:91]
    s_nop 0
    v_permlane32_swap_b32 v10, v11
    v_permlane32_swap_b32 v12, v13
    v_add_f32 v10, v10, v11
    v_add_f32 v12, v12, v13
    s_nop 1
    v_permlane16_swap_b32 v10, v12
    v_add_f32 v10, v10, v12
    s_nop 1
    v_add_f32_dpp v10, v10, v10 row_ror:4 row_mask:0xf bank_mask:0xf
    s_nop 1
    v_add_f32_dpp v10, v10, v10 row_ror:8 row_mask:0xf bank_mask:0xf
    v_cvt_pk_bf16_f32 v10, v10, v10
    v_and_b32 v10, 0xffff0000, v10
    v_add_f32 v10, v10, v16
    v_cvt_pk_bf16_f32 v10, v10, v10
    s_mov_b32 exec_lo, 0x000f000f
    s_mov_b32 exec_hi, 0x000f000f
    buffer_store_short v10, v40, s[76:79], 0 offen nt
L_end:
    s_endpgm
L_dyn:
    s_mov_b32 s14, 0x40000
L_cnt:
    v_readfirstlane_b32 s15, v15
    s_cmp_ge_u32 s15, 256
    s_cbranch_scc1 L_cntok
    buffer_load_dword v15, v54, s[60:63], 0 offen offset:128 sc1
    s_waitcnt vmcnt(0)
    s_sub_u32 s14, s14, 1
    s_cbranch_scc0 L_cnt
    v_mov_b32 v52, 2048
    s_branch L_dynback
L_cntok:
    v_mov_b32 v52, 1
    buffer_atomic_add v52, v54, s[56:59], s88 offen sc0 sc1
    s_branch L_dynback
L_wload:
    s_mov_b32 s90, -1
    s_cmp_ge_u32 s5, 18
    s_cbranch_scc1 L_wo_a
    s_bitcmp1_b32 s6, 1
    s_cbranch_scc1 L_w2_a
    s_mov_b32 s64, s28
    s_mov_b32 s65, s29
    s_mov_b32 s66, 0x510000
    s_mov_b32 s67, 0x20000
    s_mov_b32 s68, s30
    s_mov_b32 s69, s31
    s_mov_b32 s70, 0x510000
    s_mov_b32 s71, 0x20000
    v_lshrrev_b32 v32, 3, v0
    v_and_b32 v33, 48, v0
    v_add_u32 v32, v32, v33
    s_mul_i32 s14, s3, 663552
    s_lshl_b32 s15, s9, 6
    s_add_u32 s14, s14, s15
    v_and_b32 v33, 3, v0
    v_lshlrev_b32 v33, 4, v33
    v_add_u32 v33, s14, v33
    s_movk_i32 s15, 9216
    v_mad_u32_u24 v35, v32, s15, v33
    s_mov_b32 exec_lo, 0xf0f0f0f
    s_mov_b32 exec_hi, 0xf0f0f0f
    s_mov_b32 s14, 0
    buffer_load_dwordx4 v[184:187], v35, s[64:67], s14 offen nt
    s_mov_b32 s14, 18432
    buffer_load_dwordx4 v[188:191], v35, s[64:67], s14 offen nt
    s_mov_b32 s14, 36864
    buffer_load_dwordx4 v[192:195], v35, s[64:67], s14 offen nt
    s_mov_b32 s14, 55296
    buffer_load_dwordx4 v[196:199], v35, s[64:67], s14 offen nt
    s_mov_b32 s14, 73728
    buffer_load_dwordx4 v[200:203], v35, s[64:67], s14 offen nt
    s_mov_b32 s14, 92160
    buffer_load_dwordx4 v[204:207], v35, s[64:67], s14 offen nt
    s_mov_b32 s14, 110592
    buffer_load_dwordx4 v[208:211], v35, s[64:67], s14 offen nt
    s_mov_b32 s14, 129024
    buffer_load_dwordx4 v[212:215], v35, s[64:67], s14 offen nt
    s_mov_b32 s14, 147456
    buffer_load_dwordx4 v[216:219], v35, s[64:67], s14 offen nt
    s_mov_b32 exec_lo, 0xf0f0f0f0
    s_mov_b32 exec_hi, 0xf0f0f0f0
    s_mov_b32 s14, 0
    buffer_load_dwordx4 v[184:187], v35, s[68:71], s14 offen nt
    s_mov_b32 s14, 18432
    buffer_load_dwordx4 v[188:191], v35, s[68:71], s14 offen nt
    s_mov_b64 exec, -1
    s_branch L_wdone
L_w2_a:
    s_mov_b32 s64, s28
    s_mov_b32 s65, s29
    s_mov_b32 s66, 0x510000
    s_mov_b32 s67, 0x20000
    s_mov_b32 s68, s30
    s_mov_b32 s69, s31
    s_mov_b32 s70, 0x510000
    s_mov_b32 s71, 0x20000
    v_lshrrev_b32 v32, 3, v0
    v_and_b32 v33, 48, v0
    v_add_u32 v32, v32, v33
    s_mul_i32 s14, s3, 663552
    s_lshl_b32 s15, s9, 6
    s_add_u32 s14, s14, s15
    v_and_b32 v33, 3, v0
    v_lshlrev_b32 v33, 4, v33
    v_add_u32 v33, s14, v33
    s_movk_i32 s15, 9216
    v_mad_u32_u24 v35, v32, s15, v33
    s_mov_b32 exec_lo, 0xf0f0f0f
    s_mov_b32 exec_hi, 0xf0f0f0f
    s_mov_b32 s14, 0
    buffer_load_dwordx4 v[184:187], v35, s[64:67], s14 offen nt
    s_mov_b32 s14, 18432
    buffer_load_dwordx4 v[188:191], v35, s[64:67], s14 offen nt
    s_mov_b32 s14, 36864
    buffer_load_dwordx4 v[192:195], v35, s[64:67], s14 offen nt
    s_mov_b32 s14, 55296
    buffer_load_dwordx4 v[196:199], v35, s[64:67], s14 offen nt
    s_mov_b32 s14, 73728
    buffer_load_dwordx4 v[200:203], v35, s[64:67], s14 offen nt
    s_mov_b32 s14, 92160
    buffer_load_dwordx4 v[204:207], v35, s[64:67], s14 offen nt
    s_mov_b32 s14, 110592
    buffer_load_dwordx4 v[208:211], v35, s[64:67], s14 offen nt
    s_mov_b32 s14, 129024
    buffer_load_dwordx4 v[212:215], v35, s[64:67], s14 offen nt
    s_mov_b32 s14, 147456
    buffer_load_dwordx4 v[216:219], v35, s[64:67], s14 offen nt
    s_mov_b32 exec_lo, 0xf0f0f0f0
    s_mov_b32 exec_hi, 0xf0f0f0f0
    s_mov_b32 s14, 0
    buffer_load_dwordx4 v[184:187], v35, s[68:71], s14 offen nt
    s_mov_b32 s14, 18432
    buffer_load_dwordx4 v[188:191], v35, s[68:71], s14 offen nt
    s_mov_b32 s14, 36864
    buffer_load_dwordx4 v[192:195], v35, s[68:71], s14 offen nt
    s_mov_b32 s14, 55296
    buffer_load_dwordx4 v[196:199], v35, s[68:71], s14 offen nt
    s_mov_b32 s14, 73728
    buffer_load_dwordx4 v[200:203], v35, s[68:71], s14 offen nt
    s_mov_b64 exec, -1
    s_branch L_wdone
L_wo_a:
    s_branch L_wdone
L_slow1:
    v_mov_b32 v17, v16
    s_nop 1
    v_max_f32_dpp v17, v17, v17 quad_perm:[1,0,3,2] row_mask:0xf bank_mask:0xf
    s_nop 1
    v_max_f32_dpp v17, v17, v17 row_half_mirror row_mask:0xf bank_mask:0xf
    s_nop 1
    v_max_f32_dpp v17, v17, v17 row_ror:8 row_mask:0xf bank_mask:0xf
    v_mov_b32 v18, v17
    s_nop 1
    v_permlane16_swap_b32 v18, v17
    v_max_f32 v17, v18, v17
    v_mov_b32 v18, v17
    s_nop 1
    v_permlane32_swap_b32 v18, v17
    v_max_f32 v17, v18, v17
    v_sub_f32 v18, v55, v17
    v_mul_f32 v18, 0x3fb8aa3b, v18
    v_exp_f32 v18, v18
    v_mov_b32 v55, v17
    v_mul_f32 v14, v14, v18
    v_mul_f32 v10, v10, v18
    v_mul_f32 v11, v11, v18
    v_mul_f32 v12, v12, v18
    v_mul_f32 v13, v13, v18
    s_branch L_back1
L_slow2:
    v_mov_b32 v17, v16
    s_nop 1
    v_max_f32_dpp v17, v17, v17 quad_perm:[1,0,3,2] row_mask:0xf bank_mask:0xf
    s_nop 1
    v_max_f32_dpp v17, v17, v17 row_half_mirror row_mask:0xf bank_mask:0xf
    s_nop 1
    v_max_f32_dpp v17, v17, v17 row_ror:8 row_mask:0xf bank_mask:0xf
    v_mov_b32 v18, v17
    s_nop 1
    v_permlane16_swap_b32 v18, v17
    v_max_f32 v17, v18, v17
    v_mov_b32 v18, v17
    s_nop 1
    v_permlane32_swap_b32 v18, v17
    v_max_f32 v17, v18, v17
    v_sub_f32 v18, v55, v17
    v_mul_f32 v18, 0x3fb8aa3b, v18
    v_exp_f32 v18, v18
    v_mov_b32 v55, v17
    v_mul_f32 v14, v14, v18
    v_mul_f32 v10, v10, v18
    v_mul_f32 v11, v11, v18
    v_mul_f32 v12, v12, v18
    v_mul_f32 v13, v13, v18
    s_branch L_back2
L_slow0:
    v_mov_b32 v17, v16
    s_nop 1
    v_max_f32_dpp v17, v17, v17 quad_perm:[1,0,3,2] row_mask:0xf bank_mask:0xf
    s_nop 1
    v_max_f32_dpp v17, v17, v17 row_half_mirror row_mask:0xf bank_mask:0xf
    s_nop 1
    v_max_f32_dpp v17, v17, v17 row_ror:8 row_mask:0xf bank_mask:0xf
    v_mov_b32 v18, v17
    s_nop 1
    v_permlane16_swap_b32 v18, v17
    v_max_f32 v17, v18, v17
    v_mov_b32 v18, v17
    s_nop 1
    v_permlane32_swap_b32 v18, v17
    v_max_f32 v17, v18, v17
    v_sub_f32 v18, v55, v17
    v_mul_f32 v18, 0x3fb8aa3b, v18
    v_exp_f32 v18, v18
    v_mov_b32 v55, v17
    v_mul_f32 v14, v14, v18
    v_mul_f32 v10, v10, v18
    v_mul_f32 v11, v11, v18
    v_mul_f32 v12, v12, v18
    v_mul_f32 v13, v13, v18
    s_branch L_back0
L_slow9:
    v_mov_b32 v17, v16
    s_nop 1
    v_max_f32_dpp v17, v17, v17 quad_perm:[1,0,3,2] row_mask:0xf bank_mask:0xf
    s_nop 1
    v_max_f32_dpp v17, v17, v17 row_half_mirror row_mask:0xf bank_mask:0xf
    s_nop 1
    v_max_f32_dpp v17, v17, v17 row_ror:8 row_mask:0xf bank_mask:0xf
    v_mov_b32 v18, v17
    s_nop 1
    v_permlane16_swap_b32 v18, v17
    v_max_f32 v17, v18, v17
    v_mov_b32 v18, v17
    s_nop 1
    v_permlane32_swap_b32 v18, v17
    v_max_f32 v17, v18, v17
    v_sub_f32 v18, v55, v17
    v_mul_f32 v18, 0x3fb8aa3b, v18
    v_exp_f32 v18, v18
    v_mov_b32 v55, v17
    v_mul_f32 v14, v14, v18
    v_mul_f32 v10, v10, v18
    v_mul_f32 v11, v11, v18
    v_mul_f32 v12, v12, v18
    v_mul_f32 v13, v13, v18
    s_branch L_back9
.section .rodata,"a"
.p2align 6
.amdhsa_kernel sequential_preLN__mha_block_cached__glu_gated_bilinear__decode_kernel
  .amdhsa_next_free_vgpr 256
  .amdhsa_next_free_sgpr 102
  .amdhsa_accum_offset 256
  .amdhsa_group_segment_fixed_size 0
  .amdhsa_kernarg_size 96
  .amdhsa_user_sgpr_count 2
  .amdhsa_user_sgpr_kernarg_segment_ptr 1
  .amdhsa_system_sgpr_workgroup_id_x 1
.end_amdhsa_kernel
```
